```python
import torch

def _softmax(x, axis=-1):
    return torch.softmax(x, dim=axis)

def _gelu(x):
    return torch.nn.functional.gelu(x, approximate='tanh')

def _silu(x):
    return torch.nn.functional.silu(x)

def _sigmoid(x):
    return torch.sigmoid(x)

def _layernorm(x, axis=-1, eps=1e-05):
    m = x.mean(dim=axis, keepdim=True)
    v = x.var(dim=axis, keepdim=True, unbiased=False)
    return (x - m) / torch.sqrt(v + eps)

def _scatter_add(tgt, idx, src, axis=0):
    return tgt.clone().index_add_(axis, idx, src)

def _segment_sum(src, seg, n):
    out = torch.zeros((n,) + src.shape[1:], dtype=src.dtype)
    return out.index_add_(0, seg, src)

def _pad(x, pw):
    flat = tuple((v for pair in reversed(pw) for v in pair))
    return torch.nn.functional.pad(x, flat)
kernel_name = 'adaLN_cond__ssm_conv_s4d__glu_gated_glu__prompt'

def setup_inputs():

    _w = lambda a: (lambda t: t.to(torch.bfloat16) if t.is_floating_point() else t)(torch.as_tensor(a))

    def _A_setup():
        Bsz, L, D, N = (1, 2048, 512, 128)
        return {'u': _w((lambda *s: torch.randn(*s, dtype=torch.bfloat16) * 0.05)(Bsz, L, D)), 'log_A_real': _w((lambda *s: torch.randn(*s, dtype=torch.bfloat16) * 3.2)(D, N) * 0.5), 'A_imag': _w((lambda *s: torch.randn(*s, dtype=torch.bfloat16) * 0.1)(D, N) * 3.14), 'C_real': _w((lambda *s: torch.randn(*s, dtype=torch.bfloat16) * 0.4)(D, N) / N ** 0.5), 'C_imag': _w((lambda *s: torch.randn(*s, dtype=torch.bfloat16) * 0.4)(D, N) / N ** 0.5), 'log_dt': _w((lambda *s: torch.randn(*s, dtype=torch.bfloat16) * 0.1)(D) * 0.5 - 4.0), 'D_skip': _w((lambda *s: torch.randn(*s, dtype=torch.bfloat16) * 0.1)(D))}
    _A_in = _A_setup()

    def _B_setup():
        B, S, D, F = (1, 2048, 512, 1792)
        return {'x': _w((lambda *s: torch.randn(*s, dtype=torch.bfloat16) * 0.05)(B, S, D)), 'w_gate': _w((lambda *s: torch.randn(*s, dtype=torch.bfloat16) * 0.05)(D, F)), 'w_up': _w((lambda *s: torch.randn(*s, dtype=torch.bfloat16) * 0.05)(D, F)), 'w_down': _w((lambda *s: torch.randn(*s, dtype=torch.bfloat16) * 0.05)(F, D))}
    _B_in = _B_setup()
    return {'A_u': _A_in['u'], 'A_log_A_real': _A_in['log_A_real'], 'A_A_imag': _A_in['A_imag'], 'A_C_real': _A_in['C_real'], 'A_C_imag': _A_in['C_imag'], 'A_log_dt': _A_in['log_dt'], 'A_D_skip': _A_in['D_skip'], 'B_x': _B_in['x'], 'B_w_gate': _B_in['w_gate'], 'B_w_up': _B_in['w_up'], 'B_w_down': _B_in['w_down'], 'c': _w((lambda *s: torch.randn(*s, dtype=torch.bfloat16) * 0.1)(1, 512) * 8.0), 'w_mod': _w((lambda *s: torch.randn(*s, dtype=torch.bfloat16) * 0.1)(512, 6 * 512) * 512 ** (-0.5) * 8.0)}

def reference(A_u, A_log_A_real, A_A_imag, A_C_real, A_C_imag, A_log_dt, A_D_skip, B_x, B_w_gate, B_w_up, B_w_down, c, w_mod):

    def _A_ref(u, log_A_real, A_imag, C_real, C_imag, log_dt, D_skip):
        L = u.shape[1]
        dt = torch.exp(log_dt)
        A = -torch.exp(log_A_real) + 1j * A_imag
        C = (C_real + 1j * C_imag) * dt[:, None]
        pos = (lambda x, dt: x.to(dt))(torch.arange(L), log_dt.dtype)
        P = torch.exp((A * dt[:, None])[:, :, None] * pos[None, None, :])
        K = 2.0 * torch.einsum('dn,dnl->dl', C, P).real
        L2 = 2 * L
        u_t = (lambda x, *d: x.permute(*d))(u, 0, 2, 1)
        Kf = (lambda x, *a, **k: torch.fft.rfft(x.float(), *a, **k))(K, L2)
        Uf = (lambda x, *a, **k: torch.fft.rfft(x.float(), *a, **k))(u_t, L2)
        y = (lambda x, *a, **k: torch.fft.irfft(x, *a, **k).to(torch.bfloat16))(Uf * Kf[None, :, :], L2)[:, :, :L]
        y = (lambda x, *d: x.permute(*d))(y, 0, 2, 1)
        return y + u * D_skip[None, None, :]

    def _B_ref(x, w_gate, w_up, w_down):
        g = torch.einsum('bsd,df->bsf', x, w_gate)
        u = torch.einsum('bsd,df->bsf', x, w_up)
        h = _sigmoid(g) * u
        return torch.einsum('bsf,fd->bsd', h, w_down)
    x = A_u
    mod = (_silu(c) @ w_mod).reshape(c.shape[0], 6, 1, -1)
    sa, ca, ga, sb, cb, gb = (mod[:, 0].clone(), mod[:, 1].clone(), mod[:, 2].clone(), mod[:, 3].clone(), mod[:, 4].clone(), mod[:, 5].clone())
    h = _layernorm(x, axis=-1) * (1 + ca) + sa
    x = x + ga * _A_ref(h, A_log_A_real, A_A_imag, A_C_real, A_C_imag, A_log_dt, A_D_skip)
    h = _layernorm(x, axis=-1) * (1 + cb) + sb
    x = x + gb * _B_ref(h, B_w_gate, B_w_up, B_w_down)
    return x
```

```asm
; @launch grid=(256,1,1) block=(256,1,1) lds=163840
.amdgcn_target "amdgcn-amd-amdhsa--gfx950"
.text
.globl adaLN_cond__ssm_conv_s4d__glu_gated_glu__prompt_kernel
.p2align 8
.type adaLN_cond__ssm_conv_s4d__glu_gated_glu__prompt_kernel,@function
adaLN_cond__ssm_conv_s4d__glu_gated_glu__prompt_kernel:
L_begin:
  s_cmp_ge_u32 s2, 256
  s_cbranch_scc1 L_end
  s_load_dwordx16 s[16:31], s[0:1], 0
  s_load_dwordx16 s[32:47], s[0:1], 64
  s_getpc_b64 s[48:49]
L_pc:
  v_lshrrev_b32 v1, 6, v0
  v_and_b32 v2, 63, v0
  s_and_b32 s6, s2, 0x78
  s_lshl_b32 s6, s6, 6
  v_lshl_add_u32 v4, v1, 7, s6
  v_lshl_add_u32 v4, v2, 13, v4
  s_mov_b64 exec, 15
  global_load_dword v255, v4, s[48:49]
  s_mov_b64 exec, -1
  s_lshl_b32 s7, s2, 13
  v_lshl_add_u32 v5, v1, 10, s7
  v_lshl_add_u32 v5, v0, 4, v5
  v_readfirstlane_b32 s3, v1
  s_lshr_b32 s5, s2, 3
  s_and_b32 s6, s2, 7
  s_lshl_b32 s4, s6, 5
  s_add_u32 s4, s4, s5
  s_lshl_b32 s7, s4, 9
  v_lshl_add_u32 v4, v0, 1, s7
  s_lshl_b32 s7, s4, 2
  v_lshrrev_b32 v8, 7, v0
  v_lshl_add_u32 v8, v8, 1, s7
  v_and_b32_e64 v9, 1, v0
  v_lshl_add_u32 v6, v9, 1, s7
  s_and_b32 s6, s2, 3
  s_lshl_b32 s7, s6, 8
  v_lshl_add_u32 v7, v2, 2, s7
  v_mov_b32 v252, 0
  v_lshlrev_b32 v3, 4, v2
  s_waitcnt lgkmcnt(0)
  s_nop 0
  global_load_dwordx4 v[12:15], v5, s[16:17]
  global_load_dwordx4 v[16:19], v5, s[16:17] offset:1024
  global_load_ushort v20, v8, s[26:27]
  global_load_ushort v21, v4, s[18:19]
  global_load_ushort v22, v4, s[20:21]
  global_load_ushort v23, v4, s[22:23]
  global_load_ushort v24, v4, s[24:25]
  global_load_ushort v253, v6, s[28:29]
  global_load_dword v25, v7, s[38:39]
  global_load_dword v185, v252, s[46:47] offset:0 sc1
  s_mov_b64 s[8:9], s[46:47]
  s_mov_b64 s[12:13], s[42:43]
  s_mov_b64 s[20:21], s[40:41]
  s_mov_b64 s[28:29], s[36:37]
  s_mov_b64 s[44:45], s[32:33]
  s_mov_b64 s[46:47], s[34:35]
  s_mov_b32 s10, 18219008
  s_mov_b32 s11, 0x20000
  s_mov_b32 s22, 3145728
  s_mov_b32 s23, 0x20000
  s_lshl_b32 s6, s6, 2
  s_add_u32 s6, s6, s3
  s_mul_i32 s55, s6, 196608
  s_lshr_b32 s7, s2, 2
  s_lshl_b32 s7, s7, 7
  s_add_u32 s55, s55, s7
  s_cmp_ge_u32 s2, 192
  s_cselect_b32 s55, 0x7f000000, s55
  s_lshl_b32 s81, s3, 12
  s_lshl_b32 s80, s3, 11
  s_add_u32 s80, s80, 98304
  s_add_u32 m0, s81, 133888
  v_lshrrev_b32 v10, 3, v2
  v_and_b32 v1, 7, v2
  v_lshlrev_b32 v1, 4, v1
  v_and_b32 v11, 16, v2
  v_lshlrev_b32 v11, 1, v11
  v_xor_b32_e64 v11, v11, v1
  v_mul_u32_u24 v8, 6144, v10
  v_add_u32 v8, v8, v11
  v_xor_b32 v186, 64, v8
  s_lshr_b32 s6, s2, 1
  s_lshl_b32 s58, s6, 5
  s_and_b32 s7, s2, 1
  s_add_u32 s58, s58, s7
  s_lshl_b32 s58, s58, 2
  s_add_u32 s58, s58, s3
  s_lshl_b32 s58, s58, 7
  s_add_u32 s59, s58, 8192
  s_mov_b32 s30, 1835008
  s_mov_b32 s31, 0x20000
  v_and_b32 v26, 15, v2
  v_lshrrev_b32 v27, 4, v2
  v_and_b32 v28, 3, v2
  v_bfe_u32 v29, v2, 2, 2
  s_mul_i32 s7, s3, 2176
  s_add_u32 s7, s7, 125184
  v_add_u32 v30, s7, v3
  v_lshlrev_b32 v4, 3, v28
  v_lshl_add_u32 v5, v27, 5, v4
  v_mul_u32_u24 v31, 1088, v29
  s_lshl_b32 s6, s3, 8
  s_add_u32 s7, s6, 125184
  v_add3_u32 v31, v31, v5, s7
  v_mul_u32_u24 v32, 33024, v10
  v_add_u32 v32, v32, v1
  v_lshl_add_u32 v33, v10, 10, v1
  v_mul_u32_u24 v34, 3584, v10
  v_add_u32 v34, v34, v11
  v_xor_b32 v187, 64, v34
  s_add_u32 s6, s6, 150272
  v_lshl_add_u32 v37, v2, 2, s6
  v_lshl_add_u32 v38, v27, 4, s6
  s_mul_i32 s56, s3, 528384
  s_lshl_b32 s7, s2, 7
  s_add_u32 s56, s56, s7
  s_add_u32 s56, s56, 1048576
  s_add_u32 s57, s56, 264192
  s_mov_b32 s32, 0x3fb8aa3b
  s_mov_b32 s33, 0x3f803f80
  s_mov_b32 s34, 0x3b000000
  s_mov_b32 s35, 0x3727c5ac
  s_mov_b32 s14, 2097152
  s_mov_b32 s15, 0x20000
  s_and_b32 s36, s2, 3
  s_lshr_b32 s38, s2, 2
  s_lshl_b32 s37, s36, 2
  s_add_u32 s37, s37, s3
  s_mul_i32 s67, s36, 24576
  s_lshl_b32 s7, s38, 9
  s_add_u32 s67, s67, s7
  s_lshl_b32 s7, s3, 7
  s_add_u32 s67, s67, s7
  s_add_u32 s67, s67, 524288
  s_cmp_ge_u32 s2, 192
  s_cselect_b32 s67, 0x7f000000, s67
  s_cmp_ge_u32 s38, 28
  s_cselect_b32 s39, 1, 0
  s_cselect_b32 s7, 28, 0
  s_cselect_b32 s24, s46, s44
  s_cselect_b32 s25, s47, s45
  s_sub_u32 s38, s38, s7
  s_mov_b32 s26, 1835008
  s_mov_b32 s27, 0x20000
  s_mul_i32 s60, s37, 114688
  s_lshl_b32 s7, s38, 7
  s_add_u32 s60, s60, s7
  s_lshl_b32 s38, s38, 2
  s_add_u32 s38, s38, s3
  s_lshr_b32 s6, s2, 1
  s_and_b32 s7, s2, 1
  s_lshl_b32 s7, s7, 2
  s_add_u32 s7, s7, s3
  s_mul_i32 s61, s7, 112
  s_add_u32 s61, s61, s6
  s_lshl_b32 s61, s61, 11
  s_add_u32 s61, s61, 9043968
  s_lshl_b32 s62, s38, 2
  s_add_u32 s62, s62, s36
  s_lshl_b32 s62, s62, 3
  s_add_u32 s62, s62, s39
  s_lshl_b32 s62, s62, 10
  s_add_u32 s62, s62, 5373952
  s_mul_i32 s63, s36, 112
  s_add_u32 s63, s63, s38
  s_lshl_b32 s63, s63, 1
  s_add_u32 s63, s63, s39
  s_lshl_b32 s63, s63, 7
  s_nop 0
  s_add_u32 s63, s63, 131072
  s_cmp_ge_u32 s2, 224
  s_cselect_b32 s60, 0x7f000000, s60
  s_cselect_b32 s61, 0x7f000000, s61
  s_cselect_b32 s62, 0x7f000000, s62
  s_cselect_b32 s63, 0x7f000000, s63
  s_lshl_b32 s6, s2, 6
  s_add_u32 s66, s6, 4096
  s_lshl_b32 s6, s2, 7
  s_add_u32 s64, s6, 32768
  s_cmp_lg_u32 s3, 0
  s_cselect_b32 s66, 0x7f000000, s66
  s_cselect_b32 s64, 0x7f000000, s64
  s_add_u32 s65, s64, 622592
  s_lshl_b32 s7, s3, 11
  s_add_u32 s81, s81, 81920
  s_add_u32 s68, s7, 4096
  s_add_u32 s69, s68, 8192
  s_mul_i32 s82, s3, 17408
  v_mul_u32_u24 v39, 272, v2
  v_add_u32 v39, s82, v39
  v_and_b32 v7, 1, v27
  v_lshrrev_b32_e64 v11, 1, v29
  v_lshl_add_u32 v1, v7, 1, v11
  v_lshl_add_u32 v6, v27, 3, v29
  v_lshl_add_u32 v35, v6, 7, v4
  v_xor_b32_e64 v11, s3, v1
  v_lshl_add_u32 v35, v11, 5, v35
  v_add_u32 v36, 133888, v35
  v_add_u32 v35, 81920, v35
  v_lshlrev_b32 v1, 2, v1
  v_and_b32 v11, 2, v27
  v_add_u32_e64 v1, v1, v11
  v_mul_u32_u24 v1, 272, v1
  v_and_b32_e64 v11, 1, v29
  v_lshl_add_u32 v1, v11, 5, v1
  v_add3_u32 v150, v1, v4, s82
  v_mov_b32 v252, 0
  v_lshrrev_b32 v1, 5, v0
  s_mov_b32 s6, 152064
  v_lshl_add_u32 v151, v1, 2, s6
  v_lshl_add_u32 v152, v26, 2, s6
  v_lshlrev_b32_e64 v247, 3, v26
  v_mul_u32_u24 v1, 1280, v1
  v_and_b32_e64 v11, 31, v0
  v_lshl_add_u32 v1, v11, 2, v1
  v_add_u32 v1, 114944, v1
  ds_write_b32 v1, v252
  v_lshl_add_u32 v153, v29, 7, v5
  v_add_u32 v153, s80, v153
  v_and_b32 v1, 60, v2
  v_xor_b32 v1, v1, v4
  v_lshlrev_b32 v1, 2, v1
  v_lshl_add_u32 v154, v28, 9, v1
  v_add_u32 v154, s80, v154
  s_and_b32 s77, s2, 1
  s_lshl_b32 s77, s77, 2
  s_lshr_b32 s6, s5, 3
  s_add_u32 s77, s77, s6
  v_lshrrev_b32 v1, 1, v27
  v_mul_u32_u24 v1, 14336, v1
  v_lshl_add_u32 v1, v7, 8, v1
  v_lshl_add_u32 v176, v26, 4, v1
  s_lshl_b32 s48, s77, 2
  s_add_u32 s48, s48, s3
  s_mul_i32 s48, s48, 57344
  s_add_u32 s48, s48, 9043968
  s_add_u32 s49, s48, 28672
  v_lshlrev_b32 v188, 2, v2
  s_lshl_b32 s7, s2, 2
  s_add_u32 s7, s7, s3
  s_lshl_b32 s7, s7, 7
  s_add_u32 s64, s7, 917504
  buffer_load_dwordx4 v8, s[20:23], s55 offen lds
  s_add_u32 m0, m0, 1024
  s_add_u32 s55, s55, 49152
  buffer_load_dwordx4 v186, s[20:23], s55 offen lds
  s_add_u32 m0, m0, 1024
  s_add_u32 s55, s55, 49152
  buffer_load_dwordx4 v8, s[20:23], s55 offen lds
  s_add_u32 m0, m0, 1024
  s_add_u32 s55, s55, 49152
  buffer_load_dwordx4 v186, s[20:23], s55 offen lds
  s_waitcnt vmcnt(12)
  s_nop 0
  ds_write_b128 v30, v[12:15]
  ds_write_b128 v30, v[16:19] offset:1088
  v_dot2_f32_bf16 v40, v12, s33, 0
  v_dot2_f32_bf16 v41, v16, s33, 0
  v_dot2_f32_bf16 v40, v13, s33, v40
  v_dot2_f32_bf16 v41, v17, s33, v41
  v_dot2_f32_bf16 v40, v14, s33, v40
  v_dot2_f32_bf16 v41, v18, s33, v41
  v_dot2_f32_bf16 v40, v15, s33, v40
  v_dot2_f32_bf16 v41, v19, s33, v41
  v_min_u32 v1, 27, v2
  v_lshlrev_b32 v177, 10, v1
  s_mul_i32 s76, s3, 224
  s_add_u32 s76, s76, s77
  s_lshl_b32 s76, s76, 7
  s_add_u32 s76, s76, 917504
  s_waitcnt lgkmcnt(0)
  s_barrier
  ds_read_b64_tr_b16 v[48:49], v31 offset:0
  ds_read_b64_tr_b16 v[50:51], v31 offset:4352
  ds_read_b64_tr_b16 v[52:53], v31 offset:128
  ds_read_b64_tr_b16 v[54:55], v31 offset:4480
  v_dot2_f32_bf16 v42, v12, v12, 0
  v_dot2_f32_bf16 v43, v16, v16, 0
  v_dot2_f32_bf16 v42, v13, v13, v42
  v_dot2_f32_bf16 v43, v17, v17, v43
  v_dot2_f32_bf16 v42, v14, v14, v42
  v_dot2_f32_bf16 v43, v18, v18, v43
  v_dot2_f32_bf16 v42, v15, v15, v42
  v_dot2_f32_bf16 v43, v19, v19, v43
  v_permlane32_swap_b32 v40, v41
  v_add_f32 v40, v40, v41
  s_mov_b32 m0, s80
  v_and_b32 v1, 32, v2
  v_xad_u32 v155, v1, v3, s80
  v_xor_b32 v178, 64, v155
  v_lshrrev_b32 v10, 1, v0
  s_waitcnt lgkmcnt(2)
  buffer_store_dwordx4 v[48:51], v32, s[8:11], s56 offen sc1
  s_waitcnt lgkmcnt(0)
  buffer_store_dwordx4 v[52:55], v32, s[8:11], s57 offen sc1
  buffer_load_dwordx4 v33, s[28:31], s58 offen lds
  s_add_u32 m0, m0, 1024
  v_lshlrev_b32_e64 v1, 7, v10
  buffer_load_dwordx4 v33, s[28:31], s59 offen lds
  v_permlane32_swap_b32 v42, v43
  v_mov_b32 v41, v40
  v_add_f32 v42, v42, v43
  s_waitcnt vmcnt(8)
  v_readfirstlane_b32 s50, v185
  v_mov_b32 v43, v42
  v_permlane16_swap_b32 v40, v41
  v_lshlrev_b32 v20, 16, v20
  v_permlane16_swap_b32 v42, v43
  v_add_f32 v40, v40, v41
  v_add_f32 v42, v42, v43
  v_lshlrev_b32 v21, 16, v21
  v_add_f32_dpp v40, v40, v40 row_ror:8 row_mask:0xf bank_mask:0xf
  v_add_f32_dpp v42, v42, v42 row_ror:8 row_mask:0xf bank_mask:0xf
  v_lshlrev_b32_e64 v12, 16, v25
  v_add_f32_dpp v40, v40, v40 row_ror:4 row_mask:0xf bank_mask:0xf
  v_add_f32_dpp v42, v42, v42 row_ror:4 row_mask:0xf bank_mask:0xf
  v_and_b32 v13, 0xffff0000, v25
  v_add_f32_dpp v40, v40, v40 row_ror:2 row_mask:0xf bank_mask:0xf
  v_add_f32_dpp v42, v42, v42 row_ror:2 row_mask:0xf bank_mask:0xf
  v_mul_f32_e64 v20, s32, v20
  v_add_f32_dpp v40, v40, v40 row_ror:1 row_mask:0xf bank_mask:0xf
  v_add_f32_dpp v42, v42, v42 row_ror:1 row_mask:0xf bank_mask:0xf
  v_mul_f32 v40, s34, v40
  v_mul_f32 v42, s34, v42
  v_fma_f32 v42, -v40, v40, v42
  v_max_f32_e64 v42, 0, v42
  v_cvt_pk_bf16_f32 v42, v42, v42
  v_lshlrev_b32 v42, 16, v42
  v_add_f32 v42, s35, v42
  v_cvt_pk_bf16_f32 v42, v42, v42
  v_lshlrev_b32 v42, 16, v42
  v_sqrt_f32 v42, v42
  v_mul_f32_e64 v21, s32, v21
  v_cvt_pk_bf16_f32 v42, v42, v40
  ds_write_b32 v151, v42
  v_mul_f32 v14, s32, v12
  v_mul_f32 v15, s32, v13
  v_exp_f32 v20, v20
  v_exp_f32 v21, v21
  v_exp_f32_e64 v14, -v14
  v_exp_f32_e64 v15, -v15
  v_lshlrev_b32 v22, 16, v22
  v_lshlrev_b32 v23, 16, v23
  v_lshlrev_b32 v24, 16, v24
  v_add_f32 v14, 1.0, v14
  v_add_f32_e64 v15, 1.0, v15
  v_cvt_pk_bf16_f32 v21, v21, v20
  v_rcp_f32 v14, v14
  v_rcp_f32 v15, v15
  v_and_b32 v20, 0xffff0000, v21
  v_lshlrev_b32 v21, 16, v21
  v_mul_f32 v21, v21, v20
  v_mul_f32 v22, v22, v20
  v_add_f32 v20, v20, v20
  v_pk_mul_f32 v[12:13], v[12:13], v[14:15]
  v_mul_f32 v14, s32, v21
  v_mul_f32 v15, 0x3e22f983, v22
  v_cvt_pk_bf16_f32 v12, v12, v13
  ds_write_b32 v37, v12
  s_mul_i32 s50, s50, 0x9e3779b1
  s_add_u32 s50, s50, 0x7f4a7c15
  v_mul_f32 v64, v23, v20
  v_mul_f32 v65, v24, v20
  v_mul_f32 v16, 0x41800000, v14
  v_mul_f32 v17, 0x41800000, v15
  v_mul_f32 v20, 0x43800000, v14
  v_mul_f32 v21, 0x43800000, v15
  v_mov_b32_e64 v19, s50
  v_exp_f32_e64 v14, -v14
  v_fract_f32_e64 v15, v15
  v_exp_f32_e64 v16, -v16
  v_fract_f32_e64 v17, v17
  v_exp_f32_e64 v20, -v20
  v_fract_f32 v21, v21
  v_cos_f32 v66, v15
  v_sin_f32 v67, v15
  v_cos_f32 v68, v17
  v_sin_f32 v69, v17
  v_cos_f32 v70, v21
  v_sin_f32_e64 v71, v21
  v_pk_mul_f32 v[66:67], v[66:67], v[14:15] op_sel_hi:[1,0]
  v_pk_mul_f32 v[68:69], v[68:69], v[16:17] op_sel_hi:[1,0]
  v_pk_mul_f32 v[70:71], v[70:71], v[20:21] op_sel_hi:[1,0]
  v_pk_mul_f32 v[72:73], v[66:67], v[66:67] op_sel:[0,0] op_sel_hi:[0,1]
  v_pk_fma_f32 v[72:73], v[66:67], v[66:67], v[72:73] op_sel:[1,1,0] op_sel_hi:[1,0,1] neg_lo:[1,0,0]
  v_pk_mul_f32 v[74:75], v[68:69], v[68:69] op_sel:[0,0] op_sel_hi:[0,1]
  v_pk_fma_f32 v[74:75], v[68:69], v[68:69], v[74:75] op_sel:[1,1,0] op_sel_hi:[1,0,1] neg_lo:[1,0,0]
  v_pk_mul_f32 v[76:77], v[64:65], v[68:69] op_sel:[0,0] op_sel_hi:[0,1]
  v_pk_fma_f32 v[76:77], v[64:65], v[68:69], v[76:77] op_sel:[1,1,0] op_sel_hi:[1,0,1] neg_lo:[1,0,0]
  v_pk_mul_f32 v[78:79], v[72:73], v[66:67] op_sel:[0,0] op_sel_hi:[0,1]
  v_pk_fma_f32 v[78:79], v[72:73], v[66:67], v[78:79] op_sel:[1,1,0] op_sel_hi:[1,0,1] neg_lo:[1,0,0]
  v_pk_mul_f32 v[80:81], v[72:73], v[72:73] op_sel:[0,0] op_sel_hi:[0,1]
  v_pk_fma_f32 v[80:81], v[72:73], v[72:73], v[80:81] op_sel:[1,1,0] op_sel_hi:[1,0,1] neg_lo:[1,0,0]
  v_pk_mul_f32 v[82:83], v[74:75], v[74:75] op_sel:[0,0] op_sel_hi:[0,1]
  v_pk_fma_f32 v[82:83], v[74:75], v[74:75], v[82:83] op_sel:[1,1,0] op_sel_hi:[1,0,1] neg_lo:[1,0,0]
  v_pk_mul_f32 v[84:85], v[64:65], v[74:75] op_sel:[0,0] op_sel_hi:[0,1]
  v_pk_fma_f32 v[84:85], v[64:65], v[74:75], v[84:85] op_sel:[1,1,0] op_sel_hi:[1,0,1] neg_lo:[1,0,0]
  v_pk_mul_f32 v[86:87], v[76:77], v[74:75] op_sel:[0,0] op_sel_hi:[0,1]
  v_pk_fma_f32 v[86:87], v[76:77], v[74:75], v[86:87] op_sel:[1,1,0] op_sel_hi:[1,0,1] neg_lo:[1,0,0]
  v_pk_mul_f32 v[88:89], v[80:81], v[66:67] op_sel:[0,0] op_sel_hi:[0,1]
  v_pk_fma_f32 v[88:89], v[80:81], v[66:67], v[88:89] op_sel:[1,1,0] op_sel_hi:[1,0,1] neg_lo:[1,0,0]
  v_pk_mul_f32 v[90:91], v[80:81], v[72:73] op_sel:[0,0] op_sel_hi:[0,1]
  v_pk_fma_f32 v[90:91], v[80:81], v[72:73], v[90:91] op_sel:[1,1,0] op_sel_hi:[1,0,1] neg_lo:[1,0,0]
  v_pk_mul_f32 v[92:93], v[80:81], v[78:79] op_sel:[0,0] op_sel_hi:[0,1]
  v_pk_fma_f32 v[92:93], v[80:81], v[78:79], v[92:93] op_sel:[1,1,0] op_sel_hi:[1,0,1] neg_lo:[1,0,0]
  v_pk_mul_f32 v[94:95], v[80:81], v[80:81] op_sel:[0,0] op_sel_hi:[0,1]
  v_pk_fma_f32 v[94:95], v[80:81], v[80:81], v[94:95] op_sel:[1,1,0] op_sel_hi:[1,0,1] neg_lo:[1,0,0]
  v_cvt_pk_bf16_f32 v40, 1.0, v66
  v_cvt_pk_bf16_f32 v41, v72, v78
  v_cvt_pk_bf16_f32 v42, v80, v88
  v_cvt_pk_bf16_f32 v43, v90, v92
  ds_write_b128 v39, v[40:43] offset:0
  v_pk_mul_f32 v[96:97], v[64:65], v[82:83] op_sel:[0,0] op_sel_hi:[0,1]
  v_pk_fma_f32 v[96:97], v[64:65], v[82:83], v[96:97] op_sel:[1,1,0] op_sel_hi:[1,0,1] neg_lo:[1,0,0]
  v_pk_mul_f32 v[98:99], v[76:77], v[82:83] op_sel:[0,0] op_sel_hi:[0,1]
  v_pk_fma_f32 v[98:99], v[76:77], v[82:83], v[98:99] op_sel:[1,1,0] op_sel_hi:[1,0,1] neg_lo:[1,0,0]
  v_pk_mul_f32 v[100:101], v[84:85], v[82:83] op_sel:[0,0] op_sel_hi:[0,1]
  v_pk_fma_f32 v[100:101], v[84:85], v[82:83], v[100:101] op_sel:[1,1,0] op_sel_hi:[1,0,1] neg_lo:[1,0,0]
  v_pk_mul_f32 v[102:103], v[86:87], v[82:83] op_sel:[0,0] op_sel_hi:[0,1]
  v_pk_fma_f32 v[102:103], v[86:87], v[82:83], v[102:103] op_sel:[1,1,0] op_sel_hi:[1,0,1] neg_lo:[1,0,0]
  v_cvt_pk_bf16_f32 v44, 0, v67
  v_cvt_pk_bf16_f32 v45, v73, v79
  v_cvt_pk_bf16_f32 v46, v81, v89
  v_cvt_pk_bf16_f32 v47, v91, v93
  ds_write_b128 v39, v[44:47] offset:32
  v_pk_mul_f32 v[104:105], v[82:83], v[82:83] op_sel:[0,0] op_sel_hi:[0,1]
  v_pk_fma_f32 v[104:105], v[82:83], v[82:83], v[104:105] op_sel:[1,1,0] op_sel_hi:[1,0,1] neg_lo:[1,0,0]
  v_pk_mul_f32 v[106:107], v[94:95], v[66:67] op_sel:[0,0] op_sel_hi:[0,1]
  v_pk_fma_f32 v[106:107], v[94:95], v[66:67], v[106:107] op_sel:[1,1,0] op_sel_hi:[1,0,1] neg_lo:[1,0,0]
  v_pk_mul_f32 v[108:109], v[94:95], v[72:73] op_sel:[0,0] op_sel_hi:[0,1]
  v_pk_fma_f32 v[108:109], v[94:95], v[72:73], v[108:109] op_sel:[1,1,0] op_sel_hi:[1,0,1] neg_lo:[1,0,0]
  v_pk_mul_f32 v[110:111], v[94:95], v[78:79] op_sel:[0,0] op_sel_hi:[0,1]
  v_pk_fma_f32 v[110:111], v[94:95], v[78:79], v[110:111] op_sel:[1,1,0] op_sel_hi:[1,0,1] neg_lo:[1,0,0]
  v_cvt_pk_bf16_f32 v48, v64, v76
  v_cvt_pk_bf16_f32 v49, v84, v86
  v_cvt_pk_bf16_f32 v50, v96, v98
  v_cvt_pk_bf16_f32 v51, v100, v102
  ds_write_b128 v39, v[48:51] offset:192
  v_pk_mul_f32 v[112:113], v[94:95], v[80:81] op_sel:[0,0] op_sel_hi:[0,1]
  v_pk_fma_f32 v[112:113], v[94:95], v[80:81], v[112:113] op_sel:[1,1,0] op_sel_hi:[1,0,1] neg_lo:[1,0,0]
  v_pk_mul_f32 v[114:115], v[94:95], v[88:89] op_sel:[0,0] op_sel_hi:[0,1]
  v_pk_fma_f32 v[114:115], v[94:95], v[88:89], v[114:115] op_sel:[1,1,0] op_sel_hi:[1,0,1] neg_lo:[1,0,0]
  v_pk_mul_f32 v[116:117], v[94:95], v[90:91] op_sel:[0,0] op_sel_hi:[0,1]
  v_pk_fma_f32 v[116:117], v[94:95], v[90:91], v[116:117] op_sel:[1,1,0] op_sel_hi:[1,0,1] neg_lo:[1,0,0]
  v_pk_mul_f32 v[118:119], v[94:95], v[92:93] op_sel:[0,0] op_sel_hi:[0,1]
  v_pk_fma_f32 v[118:119], v[94:95], v[92:93], v[118:119] op_sel:[1,1,0] op_sel_hi:[1,0,1] neg_lo:[1,0,0]
  v_cvt_pk_bf16_f32 v52, -v65, -v77
  v_cvt_pk_bf16_f32 v53, -v85, -v87
  v_cvt_pk_bf16_f32 v54, -v97, -v99
  v_cvt_pk_bf16_f32 v55, -v101, -v103
  ds_write_b128 v39, v[52:55] offset:224
  v_pk_mul_f32 v[120:121], v[64:65], v[104:105] op_sel:[0,0] op_sel_hi:[0,1]
  v_pk_fma_f32 v[120:121], v[64:65], v[104:105], v[120:121] op_sel:[1,1,0] op_sel_hi:[1,0,1] neg_lo:[1,0,0]
  v_pk_mul_f32 v[122:123], v[76:77], v[104:105] op_sel:[0,0] op_sel_hi:[0,1]
  v_pk_fma_f32 v[122:123], v[76:77], v[104:105], v[122:123] op_sel:[1,1,0] op_sel_hi:[1,0,1] neg_lo:[1,0,0]
  v_pk_mul_f32 v[124:125], v[84:85], v[104:105] op_sel:[0,0] op_sel_hi:[0,1]
  v_pk_fma_f32 v[124:125], v[84:85], v[104:105], v[124:125] op_sel:[1,1,0] op_sel_hi:[1,0,1] neg_lo:[1,0,0]
  s_waitcnt lgkmcnt(0)
  s_waitcnt vmcnt(2)
  s_barrier
  s_nop 0
  ds_read_b32 v18, v152
  ds_read_b128 v[192:195], v38 offset:0
  ds_read_b64_tr_b16 v[208:209], v36 offset:0
  ds_read_b64_tr_b16 v[210:211], v36 offset:512
  ds_read_b128 v[196:199], v38 offset:64
  ds_read_b64_tr_b16 v[212:213], v36 offset:4096
  ds_read_b64_tr_b16 v[214:215], v36 offset:4608
  s_waitcnt lgkmcnt(6)
  s_mov_b64 exec, 0xff
  buffer_store_dwordx2 v[18:19], v247, s[8:11], s66 offen sc1
  s_mov_b64 exec, -1
  ds_read_b128 v[200:203], v38 offset:128
  ds_read_b64_tr_b16 v[216:217], v36 offset:8192
  ds_read_b64_tr_b16 v[218:219], v36 offset:8704
  ds_read_b128 v[204:207], v38 offset:192
  ds_read_b64_tr_b16 v[220:221], v36 offset:12288
  ds_read_b64_tr_b16 v[222:223], v36 offset:12800
  s_mov_b32 m0, s81
  s_nop 0
  buffer_load_dwordx4 v34, s[24:27], s60 offen lds
  s_add_u32 m0, m0, 1024
  s_add_u32 s60, s60, 28672
  buffer_load_dwordx4 v187, s[24:27], s60 offen lds
  s_add_u32 m0, m0, 1024
  s_add_u32 s60, s60, 28672
  buffer_load_dwordx4 v34, s[24:27], s60 offen lds
  s_add_u32 m0, m0, 1024
  s_add_u32 s60, s60, 28672
  buffer_load_dwordx4 v187, s[24:27], s60 offen lds
  v_lshl_add_u32 v173, v9, 4, v1
  s_lshr_b32 s6, s4, 2
  s_mul_i32 s6, s6, 33024
  s_and_b32 s7, s4, 3
  s_lshl_b32 s7, s7, 5
  s_add_u32 s6, s6, s7
  s_add_u32 s74, s6, 1048576
  s_add_u32 s75, s6, 1064960
  v_lshrrev_b32 v1, 3, v0
  v_lshlrev_b32 v1, 15, v1
  s_waitcnt lgkmcnt(0)
  v_mfma_f32_16x16x32_bf16 v[12:15], v[192:195], v[208:211], 0
  v_lshl_add_u32 v1, v9, 6, v1
  v_and_b32 v11, 3, v10
  v_mfma_f32_16x16x32_bf16 v[12:15], v[196:199], v[212:215], v[12:15]
  v_lshl_add_u32 v254, v11, 4, v1
  s_lshl_b32 s78, s4, 7
  v_mfma_f32_16x16x32_bf16 v[12:15], v[200:203], v[216:219], v[12:15]
  s_add_u32 s78, s78, 3276800
  s_add_u32 s79, s78, 0x100000
  v_mfma_f32_16x16x32_bf16 v[12:15], v[204:207], v[220:223], v[12:15]
  s_mov_b32 s51, 0
  v_mov_b32 v248, -1
  v_mov_b32 v249, -1
  v_mov_b32 v250, -1
  v_mov_b32 v251, -1
  v_mul_u32_u24 v157, 24576, v29
  v_lshl_add_u32 v157, v9, 3, v157
  v_bfe_u32 v1, v2, 1, 1
  v_mov_b32_e64 v18, v12
  s_mov_b64 exec, 0xffff
  buffer_store_dwordx2 v[18:19], v247, s[8:11], s67 offen sc1
  s_mov_b64 exec, -1
  s_nop 0
  v_pk_mul_f32 v[126:127], v[86:87], v[104:105] op_sel:[0,0] op_sel_hi:[0,1]
  v_pk_fma_f32 v[126:127], v[86:87], v[104:105], v[126:127] op_sel:[1,1,0] op_sel_hi:[1,0,1] neg_lo:[1,0,0]
  v_cvt_pk_bf16_f32 v40, v94, v106
  v_cvt_pk_bf16_f32 v41, v108, v110
  v_cvt_pk_bf16_f32 v42, v112, v114
  v_cvt_pk_bf16_f32 v43, v116, v118
  ds_write_b128 v39, v[40:43] offset:16
  v_pk_mul_f32 v[128:129], v[96:97], v[104:105] op_sel:[0,0] op_sel_hi:[0,1]
  v_pk_fma_f32 v[128:129], v[96:97], v[104:105], v[128:129] op_sel:[1,1,0] op_sel_hi:[1,0,1] neg_lo:[1,0,0]
  v_pk_mul_f32 v[130:131], v[98:99], v[104:105] op_sel:[0,0] op_sel_hi:[0,1]
  v_pk_fma_f32 v[130:131], v[98:99], v[104:105], v[130:131] op_sel:[1,1,0] op_sel_hi:[1,0,1] neg_lo:[1,0,0]
  v_pk_mul_f32 v[132:133], v[100:101], v[104:105] op_sel:[0,0] op_sel_hi:[0,1]
  v_pk_fma_f32 v[132:133], v[100:101], v[104:105], v[132:133] op_sel:[1,1,0] op_sel_hi:[1,0,1] neg_lo:[1,0,0]
  v_pk_mul_f32 v[134:135], v[102:103], v[104:105] op_sel:[0,0] op_sel_hi:[0,1]
  v_pk_fma_f32 v[134:135], v[102:103], v[104:105], v[134:135] op_sel:[1,1,0] op_sel_hi:[1,0,1] neg_lo:[1,0,0]
  v_cvt_pk_bf16_f32 v44, v95, v107
  v_cvt_pk_bf16_f32 v45, v109, v111
  v_cvt_pk_bf16_f32 v46, v113, v115
  v_cvt_pk_bf16_f32 v47, v117, v119
  ds_write_b128 v39, v[44:47] offset:48
  s_waitcnt vmcnt(6)
  s_nop 0
  ds_read_b64_tr_b16 v[192:193], v153 offset:0
  ds_read_b64_tr_b16 v[194:195], v153 offset:512
  ds_read_b64_tr_b16 v[196:197], v153 offset:1024
  ds_read_b64_tr_b16 v[198:199], v153 offset:1536
  v_pk_mul_f32 v[136:137], v[70:71], v[70:71] op_sel:[0,0] op_sel_hi:[0,1]
  v_pk_fma_f32 v[136:137], v[70:71], v[70:71], v[136:137] op_sel:[1,1,0] op_sel_hi:[1,0,1] neg_lo:[1,0,0]
  v_pk_mul_f32 v[138:139], v[70:71], v[72:73] op_sel:[0,0] op_sel_hi:[0,1]
  v_pk_fma_f32 v[138:139], v[70:71], v[72:73], v[138:139] op_sel:[1,1,0] op_sel_hi:[1,0,1] neg_lo:[1,0,0]
  v_pk_mul_f32 v[140:141], v[70:71], v[80:81] op_sel:[0,0] op_sel_hi:[0,1]
  v_pk_fma_f32 v[140:141], v[70:71], v[80:81], v[140:141] op_sel:[1,1,0] op_sel_hi:[1,0,1] neg_lo:[1,0,0]
  v_pk_mul_f32 v[142:143], v[70:71], v[90:91] op_sel:[0,0] op_sel_hi:[0,1]
  v_pk_fma_f32 v[142:143], v[70:71], v[90:91], v[142:143] op_sel:[1,1,0] op_sel_hi:[1,0,1] neg_lo:[1,0,0]
  v_cvt_pk_bf16_f32 v48, v120, v122
  v_cvt_pk_bf16_f32 v49, v124, v126
  v_cvt_pk_bf16_f32 v50, v128, v130
  v_cvt_pk_bf16_f32 v51, v132, v134
  ds_write_b128 v39, v[48:51] offset:208
  v_pk_mul_f32 v[144:145], v[70:71], v[94:95] op_sel:[0,0] op_sel_hi:[0,1]
  v_pk_fma_f32 v[144:145], v[70:71], v[94:95], v[144:145] op_sel:[1,1,0] op_sel_hi:[1,0,1] neg_lo:[1,0,0]
  s_waitcnt lgkmcnt(1)
  s_nop 0
  ds_write_b128 v154, v[192:195] offset:0
  ds_write_b128 v154, v[196:199] offset:256
  ds_read_b128 v[208:211], v155 offset:0
  ds_read_b128 v[212:215], v178 offset:1024
  v_pk_mul_f32 v[146:147], v[70:71], v[108:109] op_sel:[0,0] op_sel_hi:[0,1]
  v_pk_fma_f32 v[146:147], v[70:71], v[108:109], v[146:147] op_sel:[1,1,0] op_sel_hi:[1,0,1] neg_lo:[1,0,0]
  v_pk_mul_f32 v[148:149], v[70:71], v[112:113] op_sel:[0,0] op_sel_hi:[0,1]
  v_pk_fma_f32 v[148:149], v[70:71], v[112:113], v[148:149] op_sel:[1,1,0] op_sel_hi:[1,0,1] neg_lo:[1,0,0]
  v_pk_mul_f32 v[68:69], v[70:71], v[116:117] op_sel:[0,0] op_sel_hi:[0,1]
  v_pk_fma_f32 v[68:69], v[70:71], v[116:117], v[68:69] op_sel:[1,1,0] op_sel_hi:[1,0,1] neg_lo:[1,0,0]
  v_cvt_pk_bf16_f32 v52, -v121, -v123
  v_cvt_pk_bf16_f32 v53, -v125, -v127
  v_cvt_pk_bf16_f32 v54, -v129, -v131
  v_cvt_pk_bf16_f32 v55, -v133, -v135
  ds_write_b128 v39, v[52:55] offset:240
  v_pk_mul_f32 v[74:75], v[136:137], v[70:71] op_sel:[0,0] op_sel_hi:[0,1]
  v_pk_fma_f32 v[74:75], v[136:137], v[70:71], v[74:75] op_sel:[1,1,0] op_sel_hi:[1,0,1] neg_lo:[1,0,0]
  v_pk_mul_f32 v[82:83], v[136:137], v[136:137] op_sel:[0,0] op_sel_hi:[0,1]
  v_pk_fma_f32 v[82:83], v[136:137], v[136:137], v[82:83] op_sel:[1,1,0] op_sel_hi:[1,0,1] neg_lo:[1,0,0]
  s_waitcnt lgkmcnt(1)
  s_nop 0
  buffer_store_dwordx4 v[208:211], v3, s[8:11], s61 offen offset:0 sc1
  buffer_store_dwordx4 v[212:215], v3, s[8:11], s61 offen offset:1024 sc1
  v_pk_mul_f32 v[66:67], v[136:137], v[80:81] op_sel:[0,0] op_sel_hi:[0,1]
  v_pk_fma_f32 v[66:67], v[136:137], v[80:81], v[66:67] op_sel:[1,1,0] op_sel_hi:[1,0,1] neg_lo:[1,0,0]
  v_pk_mul_f32 v[78:79], v[136:137], v[94:95] op_sel:[0,0] op_sel_hi:[0,1]
  v_pk_fma_f32 v[78:79], v[136:137], v[94:95], v[78:79] op_sel:[1,1,0] op_sel_hi:[1,0,1] neg_lo:[1,0,0]
  v_cvt_pk_bf16_f32 v40, v70, v138
  v_cvt_pk_bf16_f32 v41, v140, v142
  v_cvt_pk_bf16_f32 v42, v144, v146
  v_cvt_pk_bf16_f32 v43, v148, v68
  ds_write_b128 v39, v[40:43] offset:64
  v_pk_mul_f32 v[88:89], v[136:137], v[112:113] op_sel:[0,0] op_sel_hi:[0,1]
  v_pk_fma_f32 v[88:89], v[136:137], v[112:113], v[88:89] op_sel:[1,1,0] op_sel_hi:[1,0,1] neg_lo:[1,0,0]
  v_pk_mul_f32 v[92:93], v[74:75], v[80:81] op_sel:[0,0] op_sel_hi:[0,1]
  v_pk_fma_f32 v[92:93], v[74:75], v[80:81], v[92:93] op_sel:[1,1,0] op_sel_hi:[1,0,1] neg_lo:[1,0,0]
  v_pk_mul_f32 v[106:107], v[74:75], v[94:95] op_sel:[0,0] op_sel_hi:[0,1]
  v_pk_fma_f32 v[106:107], v[74:75], v[94:95], v[106:107] op_sel:[1,1,0] op_sel_hi:[1,0,1] neg_lo:[1,0,0]
  v_pk_mul_f32 v[110:111], v[74:75], v[112:113] op_sel:[0,0] op_sel_hi:[0,1]
  v_pk_fma_f32 v[110:111], v[74:75], v[112:113], v[110:111] op_sel:[1,1,0] op_sel_hi:[1,0,1] neg_lo:[1,0,0]
  v_cvt_pk_bf16_f32 v44, v71, v139
  v_cvt_pk_bf16_f32 v45, v141, v143
  v_cvt_pk_bf16_f32 v46, v145, v147
  v_cvt_pk_bf16_f32 v47, v149, v69
  ds_write_b128 v39, v[44:47] offset:96
  v_pk_mul_f32 v[114:115], v[82:83], v[70:71] op_sel:[0,0] op_sel_hi:[0,1]
  v_pk_fma_f32 v[114:115], v[82:83], v[70:71], v[114:115] op_sel:[1,1,0] op_sel_hi:[1,0,1] neg_lo:[1,0,0]
  v_pk_mul_f32 v[118:119], v[82:83], v[136:137] op_sel:[0,0] op_sel_hi:[0,1]
  v_pk_fma_f32 v[118:119], v[82:83], v[136:137], v[118:119] op_sel:[1,1,0] op_sel_hi:[1,0,1] neg_lo:[1,0,0]
  v_pk_mul_f32 v[104:105], v[82:83], v[74:75] op_sel:[0,0] op_sel_hi:[0,1]
  v_pk_fma_f32 v[104:105], v[82:83], v[74:75], v[104:105] op_sel:[1,1,0] op_sel_hi:[1,0,1] neg_lo:[1,0,0]
  v_pk_mul_f32 v[64:65], v[82:83], v[82:83] op_sel:[0,0] op_sel_hi:[0,1]
  v_pk_fma_f32 v[64:65], v[82:83], v[82:83], v[64:65] op_sel:[1,1,0] op_sel_hi:[1,0,1] neg_lo:[1,0,0]
  v_cvt_pk_bf16_f32 v48, v136, v66
  v_cvt_pk_bf16_f32 v49, v78, v88
  v_cvt_pk_bf16_f32 v50, v74, v92
  v_cvt_pk_bf16_f32 v51, v106, v110
  ds_write_b128 v39, v[48:51] offset:80
  v_pk_mul_f32 v[76:77], v[82:83], v[94:95] op_sel:[0,0] op_sel_hi:[0,1]
  v_pk_fma_f32 v[76:77], v[82:83], v[94:95], v[76:77] op_sel:[1,1,0] op_sel_hi:[1,0,1] neg_lo:[1,0,0]
  v_pk_mul_f32 v[84:85], v[114:115], v[94:95] op_sel:[0,0] op_sel_hi:[0,1]
  v_pk_fma_f32 v[84:85], v[114:115], v[94:95], v[84:85] op_sel:[1,1,0] op_sel_hi:[1,0,1] neg_lo:[1,0,0]
  v_pk_mul_f32 v[86:87], v[118:119], v[94:95] op_sel:[0,0] op_sel_hi:[0,1]
  v_pk_fma_f32 v[86:87], v[118:119], v[94:95], v[86:87] op_sel:[1,1,0] op_sel_hi:[1,0,1] neg_lo:[1,0,0]
  v_pk_mul_f32 v[96:97], v[104:105], v[94:95] op_sel:[0,0] op_sel_hi:[0,1]
  v_pk_fma_f32 v[96:97], v[104:105], v[94:95], v[96:97] op_sel:[1,1,0] op_sel_hi:[1,0,1] neg_lo:[1,0,0]
  v_cvt_pk_bf16_f32 v52, v137, v67
  v_cvt_pk_bf16_f32 v53, v79, v89
  v_cvt_pk_bf16_f32 v54, v75, v93
  v_cvt_pk_bf16_f32 v55, v107, v111
  ds_write_b128 v39, v[52:55] offset:112
  v_cvt_pk_bf16_f32 v56, v64, v64
  v_cvt_pk_bf16_f32 v57, v65, v65
  ds_write2_b32 v39, v56, v57 offset0:36 offset1:44
  v_cvt_pk_bf16_f32 v40, v82, v76
  v_cvt_pk_bf16_f32 v41, v114, v84
  v_cvt_pk_bf16_f32 v42, v118, v86
  v_cvt_pk_bf16_f32 v43, v104, v96
  ds_write_b128 v39, v[40:43] offset:128
  v_cvt_pk_bf16_f32 v44, v83, v77
  v_cvt_pk_bf16_f32 v45, v115, v85
  v_cvt_pk_bf16_f32 v46, v119, v87
  v_cvt_pk_bf16_f32 v47, v105, v97
  ds_write_b128 v39, v[44:47] offset:160
  ds_read_b64_tr_b16 v[76:77], v150 offset:192
  ds_read_b64_tr_b16 v[78:79], v150 offset:464
  ds_read_b64_tr_b16 v[64:65], v150 offset:0
  ds_read_b64_tr_b16 v[66:67], v150 offset:272
  ds_read_b64_tr_b16 v[68:69], v150 offset:64
  ds_read_b64_tr_b16 v[70:71], v150 offset:336
  ds_read_b64_tr_b16 v[72:73], v150 offset:128
  ds_read_b64_tr_b16 v[74:75], v150 offset:400
  ds_read_b64_tr_b16 v[92:93], v150 offset:4544
  ds_read_b64_tr_b16 v[94:95], v150 offset:4816
  ds_read_b64_tr_b16 v[80:81], v150 offset:4352
  ds_read_b64_tr_b16 v[82:83], v150 offset:4624
  s_waitcnt lgkmcnt(8)
  v_mfma_f32_16x16x32_bf16 v[40:43], v[64:67], v[76:79], 0
  ds_read_b64_tr_b16 v[84:85], v150 offset:4416
  ds_read_b64_tr_b16 v[86:87], v150 offset:4688
  s_waitcnt lgkmcnt(8)
  v_mfma_f32_16x16x32_bf16 v[44:47], v[68:71], v[76:79], 0
  ds_read_b64_tr_b16 v[88:89], v150 offset:4480
  ds_read_b64_tr_b16 v[90:91], v150 offset:4752
  s_waitcnt lgkmcnt(8)
  v_mfma_f32_16x16x32_bf16 v[48:51], v[72:75], v[76:79], 0
  ds_read_b64_tr_b16 v[108:109], v150 offset:8896
  ds_read_b64_tr_b16 v[110:111], v150 offset:9168
  ds_read_b64_tr_b16 v[96:97], v150 offset:8704
  ds_read_b64_tr_b16 v[98:99], v150 offset:8976
  s_waitcnt lgkmcnt(8)
  v_mfma_f32_16x16x32_bf16 v[40:43], v[80:83], v[92:95], v[40:43]
  ds_read_b64_tr_b16 v[100:101], v150 offset:8768
  ds_read_b64_tr_b16 v[102:103], v150 offset:9040
  s_waitcnt lgkmcnt(8)
  v_mfma_f32_16x16x32_bf16 v[44:47], v[84:87], v[92:95], v[44:47]
  ds_read_b64_tr_b16 v[104:105], v150 offset:8832
  ds_read_b64_tr_b16 v[106:107], v150 offset:9104
  s_waitcnt lgkmcnt(8)
  v_mfma_f32_16x16x32_bf16 v[48:51], v[88:91], v[92:95], v[48:51]
  ds_read_b64_tr_b16 v[124:125], v150 offset:13248
  ds_read_b64_tr_b16 v[126:127], v150 offset:13520
  ds_read_b64_tr_b16 v[112:113], v150 offset:13056
  ds_read_b64_tr_b16 v[114:115], v150 offset:13328
  s_waitcnt lgkmcnt(8)
  v_mfma_f32_16x16x32_bf16 v[40:43], v[96:99], v[108:111], v[40:43]
  ds_read_b64_tr_b16 v[116:117], v150 offset:13120
  ds_read_b64_tr_b16 v[118:119], v150 offset:13392
  s_waitcnt lgkmcnt(8)
  v_mfma_f32_16x16x32_bf16 v[44:47], v[100:103], v[108:111], v[44:47]
  ds_read_b64_tr_b16 v[120:121], v150 offset:13184
  ds_read_b64_tr_b16 v[122:123], v150 offset:13456
  s_waitcnt lgkmcnt(8)
  s_nop 0
  v_mfma_f32_16x16x32_bf16 v[48:51], v[104:107], v[108:111], v[48:51]
  buffer_load_dwordx4 v[224:227], v3, s[8:11], s68 offen offset:0 sc1
  buffer_load_dwordx4 v[228:231], v3, s[8:11], s68 offen offset:1024 sc1
  buffer_load_dwordx4 v[232:235], v3, s[8:11], s69 offen offset:0 sc1
  buffer_load_dwordx4 v[236:239], v3, s[8:11], s69 offen offset:1024 sc1
  v_lshl_add_u32 v156, v1, 12, v157
  s_lshl_b32 s70, s4, 4
  s_add_u32 s70, s70, 524288
  s_add_u32 s71, s70, 8192
  v_mul_u32_u24 v158, 24576, v27
  v_lshl_add_u32 v158, v26, 4, v158
  s_lshl_b32 s72, s37, 8
  s_add_u32 s72, s72, 536576
  s_waitcnt lgkmcnt(4)
  v_mfma_f32_16x16x32_bf16 v[40:43], v[112:115], v[124:127], v[40:43]
  s_add_u32 s73, s72, 4096
  s_mul_i32 s7, s3, 3072
  s_waitcnt lgkmcnt(2)
  v_mfma_f32_16x16x32_bf16 v[44:47], v[116:119], v[124:127], v[44:47]
  s_add_u32 s7, s7, 69632
  v_lshl_add_u32 v1, v27, 4, s7
  s_waitcnt lgkmcnt(0)
  v_mfma_f32_16x16x32_bf16 v[48:51], v[120:123], v[124:127], v[48:51]
  v_lshl_add_u32 v159, v26, 6, v1
  v_lshl_add_u32 v160, v26, 5, v1
  v_lshl_add_u32 v1, v27, 8, s7
  v_cmp_gt_u32 vcc, 2, v27
  ds_write_b128 v159, v[40:43]
  v_lshl_add_u32 v11, v26, 4, v1
  v_add_u32 v161, v247, v1
  v_cndmask_b32 v160, v11, v160, vcc
  ds_write_b128 v160, v[44:47] offset:1024
  v_add_u32 v161, 2048, v161
  ds_write2_b64 v161, v[48:49], v[50:51] offset0:0 offset1:16
  s_waitcnt vmcnt(4)
  s_mov_b32 exec_hi, 0
  buffer_store_dword v19, v188, s[8:11], s64 offen sc1
  s_mov_b32 exec_hi, -1
  buffer_load_dwordx4 v[192:195], v158, s[8:11], s72 offen sc1
  buffer_load_dwordx4 v[196:199], v158, s[8:11], s73 offen sc1
  buffer_load_dwordx2 v[200:201], v156, s[8:11], s70 offen sc1
  buffer_load_dwordx2 v[202:203], v157, s[8:11], s71 offen sc1
  s_lshl_b32 s7, s3, 7
  s_add_u32 s7, s7, 151296
  v_add_u32 v174, s7, v247
  s_lshl_b32 s7, s3, 6
  s_add_u32 s7, s7, 151808
  v_lshl_add_u32 v175, v26, 2, s7
  s_mov_b32 s6, 151296
  v_lshl_add_u32 v180, v27, 5, s6
  s_mov_b32 s6, 151808
  v_lshl_add_u32 v181, v27, 4, s6
  s_waitcnt lgkmcnt(0)
  s_barrier
  v_add_u32 v182, s82, v3
  v_lshrrev_b32 v1, 1, v2
  v_lshl_add_u32 v183, v1, 6, s82
  s_lshr_b32 s6, s3, 1
  s_nop 0
  s_mul_i32 s7, s6, 6144
  s_add_u32 s7, s7, 69632
  v_and_b32 v1, 127, v0
  v_lshl_add_u32 v162, v1, 3, s7
  s_add_u32 s7, s7, 1024
  v_lshl_add_u32 v163, v1, 2, s7
  v_add_u32 v164, 1024, v163
  ds_read2_b32 v[208:209], v164 offset0:0 offset1:1
  v_add_u32 v165, 3072, v163
  v_add_u32 v166, 4096, v163
  ds_read2_b32 v[210:211], v166 offset0:0 offset1:1
  ds_read2_b32 v[212:213], v163 offset0:128 offset1:129
  ds_read2_b32 v[214:215], v165 offset0:128 offset1:129
  ds_read2_b32 v[216:217], v163 offset0:0 offset1:1
  ds_read2_b32 v[218:219], v165 offset0:0 offset1:1
  ds_read2st64_b64 v[220:223], v162 offset0:0 offset1:6
  s_mul_i32 s7, s6, 8320
  s_add_u32 s7, s7, 98336
  v_lshl_add_u32 v167, v1, 2, s7
  v_add_u32 v168, 4164, v167
  v_lshl_add_u32 v169, v1, 3, s7
  v_add_u32 v170, 5188, v169
  v_lshl_add_u32 v171, v1, 4, s7
  s_add_u32 s7, s7, 192
  v_sub_u32_e64 v1, v28, v6
  v_lshl_add_u32 v245, v1, 3, s7
  s_and_b32 s83, s3, 1
  s_lshl_b32 s7, s6, 2
  s_add_u32 s7, s7, s83
  s_nop 0
  s_mul_i32 s7, s7, 1280
  s_add_u32 s7, s7, 114952
  v_lshl_add_u32 v1, v27, 1, v26
  v_lshl_add_u32 v246, v1, 3, s7
  v_cmp_eq_u32 s[52:53], 1, v9
  s_mul_i32 s7, s3, 4160
  s_add_u32 s7, s7, 98304
  s_add_u32 s6, s83, 7
  v_min_u32 v1, s6, v26
  v_lshl_add_u32 v172, v1, 2, s7
  ds_write_b32 v172, v252
  v_mul_u32_u24 v1, 5120, v9
  v_lshl_add_u32 v189, v10, 2, v1
  v_add_u32 v189, 115072, v189
  s_waitcnt lgkmcnt(1)
  s_nop 0
  v_pk_add_f32 v[208:209], v[208:209], v[210:211]
  v_pk_add_f32 v[212:213], v[212:213], v[214:215]
  v_cndmask_b32 v210, v208, v209, s[52:53]
  v_cvt_pk_bf16_f32 v112, v208, v208
  v_cvt_pk_bf16_f32 v113, v208, v208
  v_cvt_pk_bf16_f32 v114, v210, v209
  v_cvt_pk_bf16_f32 v115, v209, v209
  ds_write_b128 v171, v[112:115] offset:2048
  v_mov_b64 v[116:117], v[112:113]
  v_mov_b32 v118, v112
  v_mov_b32_e64 v119, v114
  v_pk_add_f32 v[216:217], v[216:217], v[218:219]
  v_pk_add_f32 v[220:221], v[220:221], v[222:223]
  v_cndmask_b32 v214, v212, v213, s[52:53]
  v_cndmask_b32 v218, v216, v217, s[52:53]
  ds_write_b128 v171, v[116:119] offset:6208
  v_cvt_pk_bf16_f32 v120, v212, v212
  v_cvt_pk_bf16_f32 v121, v214, v213
  v_cvt_pk_bf16_f32 v122, v220, v221
  v_cvt_pk_bf16_f32 v123, v216, v218
  ds_write_b64 v169, v[120:121] offset:1024
  ds_write2_b32 v170, v120, v121 offset0:0 offset1:1
  ds_write2st64_b32 v167, v122, v123 offset0:0 offset1:2
  ds_write2st64_b32 v168, v122, v123 offset0:0 offset1:2
  s_waitcnt vmcnt(5)
L_c1:
  s_nop 0
  v_min3_u32 v1, v225, v227, s50
  v_max3_u32 v11, v225, v227, s50
  v_min3_u32 v1, v1, v229, v231
  v_max3_u32 v11, v11, v229, v231
  v_min3_u32 v1, v1, v233, v235
  v_max3_u32 v11, v11, v233, v235
  v_min3_u32 v1, v1, v237, v239
  v_max3_u32 v11, v11, v237, v239
  v_cmp_ne_u32 vcc, v1, v11
  s_nop 0
  s_cbranch_vccnz L_r1
L_o1:
  buffer_load_dwordx4 v[240:243], v173, s[8:11], s74 offen sc1
  buffer_load_dwordx4 v[4:7], v173, s[8:11], s75 offen sc1
  s_waitcnt vmcnt(2)
L_cm:
  v_min3_u32 v1, v193, v195, s50
  v_max3_u32 v11, v193, v195, s50
  v_min3_u32 v1, v1, v197, v199
  v_max3_u32 v11, v11, v197, v199
  v_min3_u32 v1, v1, v201, v203
  v_max3_u32 v11, v11, v201, v203
  v_cmp_ne_u32 vcc, v1, v11
  s_nop 0
  s_cbranch_vccnz L_rm
L_om:
  v_permlane32_swap_b32 v192, v196
  v_permlane32_swap_b32 v194, v198
  v_add_f32 v192, v192, v196
  v_add_f32_e64 v194, v194, v198
  v_add_f32_dpp v200, v200, v200 row_ror:8 row_mask:0xf bank_mask:0xf
  v_mov_b32 v193, v192
  v_mov_b32 v195, v194
  v_add_f32_dpp v202, v202, v202 row_ror:8 row_mask:0xf bank_mask:0xf
  v_add_f32_dpp v200, v200, v200 row_ror:4 row_mask:0xf bank_mask:0xf
  v_permlane16_swap_b32 v192, v193
  v_permlane16_swap_b32 v194, v195
  v_add_f32 v192, v192, v193
  v_add_f32 v194, v194, v195
  v_add_f32_dpp v202, v202, v202 row_ror:4 row_mask:0xf bank_mask:0xf
  v_cvt_pk_bf16_f32 v192, v192, v194
  s_mov_b32 exec_hi, 0
  ds_write_b32 v175, v192
  s_mov_b32 exec_hi, -1
  v_lshlrev_b32_e64 v194, 16, v192
  v_and_b32 v195, 0xffff0000, v192
  v_pk_add_f32 v[194:195], v[194:195], 1.0 op_sel_hi:[1,0]
  v_cvt_pk_bf16_f32 v192, v194, v195
  v_lshlrev_b32_e64 v194, 16, v192
  v_and_b32 v195, 0xffff0000, v192
  s_mov_b32 exec_lo, 0
  ds_write_b64 v174, v[194:195]
  s_mov_b32 exec_lo, -1
  v_mov_b32 v23, v176
  v_mov_b32 v8, v177
  v_lshlrev_b32 v188, 2, v2
  v_lshlrev_b32 v18, 2, v2
  v_cvt_pk_bf16_f32 v200, v200, v202
  v_and_b32 v206, 0xffff0000, v200
  v_lshlrev_b32 v200, 16, v200
  v_lshlrev_b32 v253, 16, v253
  v_add_f32 v201, 1.0, v200
  v_mul_f32 v253, v253, v206
  s_waitcnt lgkmcnt(0)
  s_barrier
  ds_read_b64_tr_b16 v[64:65], v35 offset:0
  ds_read_b64_tr_b16 v[66:67], v35 offset:512
  ds_read_b128 v[96:99], v180 offset:0
  ds_read_b128 v[100:103], v180 offset:16
  ds_read_b64_tr_b16 v[68:69], v35 offset:4096
  ds_read_b64_tr_b16 v[70:71], v35 offset:4608
  ds_read_b128 v[104:107], v180 offset:128
  ds_read_b128 v[108:111], v180 offset:144
  buffer_store_dwordx4 v[248:251], v254, s[8:11], s78 offen sc1
  buffer_store_dwordx4 v[248:251], v254, s[8:11], s79 offen sc1
  v_cvt_pk_bf16_f32 v201, v201, v201
  v_lshlrev_b32_e64 v201, 16, v201
  v_mov_b32_dpp v204, v200 quad_perm:[0,1,0,1] row_mask:0xf bank_mask:0xf
  v_mov_b32 v144, s33
  v_mov_b32 v145, s33
  v_mov_b32 v146, s33
  v_mov_b32 v147, s33
  v_mov_b32_dpp v205, v201 quad_perm:[2,3,2,3] row_mask:0xf bank_mask:0xf
  s_waitcnt lgkmcnt(4)
  v_lshlrev_b32 v40, 16, v64
  v_and_b32 v41, 0xffff0000, v64
  v_lshlrev_b32_e64 v42, 16, v65
  v_and_b32 v43, 0xffff0000, v65
  v_lshlrev_b32_e64 v44, 16, v66
  v_and_b32 v45, 0xffff0000, v66
  v_lshlrev_b32_e64 v46, 16, v67
  v_and_b32 v47, 0xffff0000, v67
  v_pk_mul_f32 v[40:41], v[40:41], v[96:97]
  v_pk_mul_f32 v[42:43], v[42:43], v[98:99]
  v_pk_mul_f32 v[44:45], v[44:45], v[100:101]
  v_pk_mul_f32 v[46:47], v[46:47], v[102:103]
  v_cvt_pk_bf16_f32 v128, v40, v41
  v_cvt_pk_bf16_f32 v129, v42, v43
  v_cvt_pk_bf16_f32 v130, v44, v45
  v_cvt_pk_bf16_f32 v131, v46, v47
  buffer_store_dwordx4 v[128:131], v3, s[8:11], s62 offen offset:0 sc1
  ds_read_b64_tr_b16 v[72:73], v35 offset:8192
  ds_read_b64_tr_b16 v[74:75], v35 offset:8704
  ds_read_b128 v[112:115], v180 offset:256
  ds_read_b128 v[116:119], v180 offset:272
  s_waitcnt lgkmcnt(4)
  v_lshlrev_b32 v40, 16, v68
  v_and_b32 v41, 0xffff0000, v68
  v_lshlrev_b32_e64 v42, 16, v69
  v_and_b32 v43, 0xffff0000, v69
  v_lshlrev_b32_e64 v44, 16, v70
  v_and_b32 v45, 0xffff0000, v70
  v_lshlrev_b32_e64 v46, 16, v71
  v_and_b32 v47, 0xffff0000, v71
  v_pk_mul_f32 v[40:41], v[40:41], v[104:105]
  v_pk_mul_f32 v[42:43], v[42:43], v[106:107]
  v_pk_mul_f32 v[44:45], v[44:45], v[108:109]
  v_pk_mul_f32 v[46:47], v[46:47], v[110:111]
  v_cvt_pk_bf16_f32 v132, v40, v41
  v_cvt_pk_bf16_f32 v133, v42, v43
  v_cvt_pk_bf16_f32 v134, v44, v45
  v_cvt_pk_bf16_f32 v135, v46, v47
  buffer_store_dwordx4 v[132:135], v3, s[8:11], s62 offen offset:2048 sc1
  ds_read_b64_tr_b16 v[76:77], v35 offset:12288
  ds_read_b64_tr_b16 v[78:79], v35 offset:12800
  ds_read_b128 v[120:123], v180 offset:384
  ds_read_b128 v[124:127], v180 offset:400
  s_add_u32 s62, s62, 4096
  s_waitcnt lgkmcnt(4)
  v_lshlrev_b32 v40, 16, v72
  v_and_b32 v41, 0xffff0000, v72
  v_lshlrev_b32_e64 v42, 16, v73
  v_and_b32 v43, 0xffff0000, v73
  v_lshlrev_b32_e64 v44, 16, v74
  v_and_b32 v45, 0xffff0000, v74
  v_lshlrev_b32_e64 v46, 16, v75
  v_and_b32 v47, 0xffff0000, v75
  v_pk_mul_f32 v[40:41], v[40:41], v[112:113]
  v_pk_mul_f32 v[42:43], v[42:43], v[114:115]
  v_pk_mul_f32 v[44:45], v[44:45], v[116:117]
  v_pk_mul_f32 v[46:47], v[46:47], v[118:119]
  v_cvt_pk_bf16_f32 v136, v40, v41
  v_cvt_pk_bf16_f32 v137, v42, v43
  v_cvt_pk_bf16_f32 v138, v44, v45
  v_cvt_pk_bf16_f32 v139, v46, v47
  buffer_store_dwordx4 v[136:139], v3, s[8:11], s62 offen offset:0 sc1
  ds_read_b128 v[80:83], v181 offset:0
  ds_read_b128 v[84:87], v181 offset:64
  ds_read_b128 v[88:91], v181 offset:128
  ds_read_b128 v[92:95], v181 offset:192
  s_waitcnt lgkmcnt(4)
  v_lshlrev_b32 v40, 16, v76
  v_and_b32 v41, 0xffff0000, v76
  v_lshlrev_b32_e64 v42, 16, v77
  v_and_b32 v43, 0xffff0000, v77
  v_lshlrev_b32_e64 v44, 16, v78
  v_and_b32 v45, 0xffff0000, v78
  v_lshlrev_b32_e64 v46, 16, v79
  v_and_b32 v47, 0xffff0000, v79
  v_pk_mul_f32 v[40:41], v[40:41], v[120:121]
  v_pk_mul_f32 v[42:43], v[42:43], v[122:123]
  v_pk_mul_f32 v[44:45], v[44:45], v[124:125]
  v_pk_mul_f32 v[46:47], v[46:47], v[126:127]
  v_cvt_pk_bf16_f32 v140, v40, v41
  v_cvt_pk_bf16_f32 v141, v42, v43
  v_cvt_pk_bf16_f32 v142, v44, v45
  v_cvt_pk_bf16_f32 v143, v46, v47
  buffer_store_dwordx4 v[140:143], v3, s[8:11], s62 offen offset:2048 sc1
  s_waitcnt lgkmcnt(0)
  v_mfma_f32_16x16x32_bf16 v[52:55], v[80:83], v[64:67], 0
  v_lshlrev_b32 v96, 16, v224
  v_mfma_f32_16x16x32_bf16 v[48:51], v[144:147], v[128:131], 0
  v_lshlrev_b32_e64 v97, 16, v226
  v_mfma_f32_16x16x32_bf16 v[52:55], v[84:87], v[68:71], v[52:55]
  v_rcp_f32_e64 v96, v96
  v_mfma_f32_16x16x32_bf16 v[48:51], v[144:147], v[132:135], v[48:51]
  v_rcp_f32_e64 v97, v97
  v_mfma_f32_16x16x32_bf16 v[52:55], v[88:91], v[72:75], v[52:55]
  v_and_b32 v98, 0xffff0000, v224
  v_mfma_f32_16x16x32_bf16 v[48:51], v[144:147], v[136:139], v[48:51]
  v_and_b32 v99, 0xffff0000, v226
  v_mfma_f32_16x16x32_bf16 v[52:55], v[92:95], v[76:79], v[52:55]
  v_mfma_f32_16x16x32_bf16 v[48:51], v[144:147], v[140:143], v[48:51]
  v_pk_mul_f32 v[98:99], v[98:99], v[96:97] neg_lo:[1,0] neg_hi:[1,0]
  ds_write_b128 v182, v[96:99] offset:0
  v_lshlrev_b32 v100, 16, v228
  v_lshlrev_b32 v101, 16, v230
  v_rcp_f32 v100, v100
  v_rcp_f32 v101, v101
  v_and_b32 v102, 0xffff0000, v228
  v_and_b32 v103, 0xffff0000, v230
  v_cvt_pk_bf16_f32 v40, v48, v52
  v_lshlrev_b32_e64 v41, 16, v40
  v_and_b32 v42, 0xffff0000, v40
  v_sub_f32 v43, v48, v41
  v_sub_f32 v44, v52, v42
  v_cvt_pk_bf16_f32 v40, v41, v43
  v_cvt_pk_bf16_f32 v41, v42, v44
  s_mov_b64 exec, 0xffff
  buffer_store_dwordx2 v[40:41], v247, s[8:11], s63 offen sc1
  s_mov_b64 exec, -1
  buffer_load_dword v255, v8, s[8:11], s76 offen sc1
  v_pk_mul_f32 v[102:103], v[102:103], v[100:101] neg_lo:[1,0] neg_hi:[1,0]
  ds_write_b128 v182, v[100:103] offset:1024
  v_lshlrev_b32 v104, 16, v232
  v_lshlrev_b32 v105, 16, v234
  v_rcp_f32 v104, v104
  v_rcp_f32_e64 v105, v105
  v_and_b32 v106, 0xffff0000, v232
  v_and_b32 v107, 0xffff0000, v234
  v_pk_mul_f32 v[106:107], v[106:107], v[104:105] neg_lo:[1,0] neg_hi:[1,0]
  ds_write_b128 v182, v[104:107] offset:2048
  v_lshlrev_b32 v108, 16, v236
  v_lshlrev_b32 v109, 16, v238
  v_rcp_f32 v108, v108
  v_rcp_f32 v109, v109
  v_and_b32 v110, 0xffff0000, v236
  v_and_b32 v111, 0xffff0000, v238
  v_pk_mul_f32 v[110:111], v[110:111], v[108:109] neg_lo:[1,0] neg_hi:[1,0]
  ds_write_b128 v182, v[108:111] offset:3072
  ds_read_b128 v[64:67], v183 offset:0
  ds_read_b128 v[68:71], v183 offset:16
  ds_read_b128 v[72:75], v183 offset:32
  ds_read_b128 v[76:79], v183 offset:48
  ds_read_b128 v[80:83], v183 offset:2048
  ds_read_b128 v[84:87], v183 offset:2064
  ds_read_b128 v[88:91], v183 offset:2080
  ds_read_b128 v[92:95], v183 offset:2096
  v_mov_b32_e64 v230, v206
  v_add_u32 v17, 2560, v246
  s_waitcnt vmcnt(8)
  v_lshlrev_b32 v32, 16, v240
  v_and_b32 v33, 0xffff0000, v240
  v_lshlrev_b32_e64 v34, 16, v241
  v_and_b32 v35, 0xffff0000, v241
  v_lshlrev_b32_e64 v36, 16, v242
  v_and_b32 v37, 0xffff0000, v242
  v_lshlrev_b32_e64 v38, 16, v243
  v_and_b32 v39, 0xffff0000, v243
  v_lshlrev_b32_e64 v40, 16, v4
  v_and_b32 v41, 0xffff0000, v4
  v_lshlrev_b32_e64 v42, 16, v5
  v_and_b32 v43, 0xffff0000, v5
  v_lshlrev_b32_e64 v44, 16, v6
  v_and_b32 v45, 0xffff0000, v6
  v_lshlrev_b32_e64 v46, 16, v7
  v_and_b32 v47, 0xffff0000, v7
  s_waitcnt lgkmcnt(0)
  s_nop 0
  v_pk_fma_f32 v[48:49], v[32:33], v[64:65], v[66:67]
  v_pk_fma_f32 v[50:51], v[34:35], v[68:69], v[70:71]
  v_pk_fma_f32 v[52:53], v[36:37], v[72:73], v[74:75]
  v_pk_fma_f32 v[54:55], v[38:39], v[76:77], v[78:79]
  v_pk_fma_f32 v[48:49], v[48:49], v[204:205], v[204:205] op_sel:[0,1,0] op_sel_hi:[1,1,0]
  v_pk_fma_f32 v[50:51], v[50:51], v[204:205], v[204:205] op_sel:[0,1,0] op_sel_hi:[1,1,0]
  v_pk_fma_f32 v[52:53], v[52:53], v[204:205], v[204:205] op_sel:[0,1,0] op_sel_hi:[1,1,0]
  v_pk_fma_f32 v[54:55], v[54:55], v[204:205], v[204:205] op_sel:[0,1,0] op_sel_hi:[1,1,0]
  v_cvt_pk_bf16_f32 v96, v48, v52
  v_cvt_pk_bf16_f32 v97, v49, v53
  v_cvt_pk_bf16_f32 v98, v50, v54
  v_cvt_pk_bf16_f32 v99, v51, v55
  ds_write2st64_b32 v189, v96, v97 offset0:0 offset1:5
  ds_write2st64_b32 v189, v98, v99 offset0:10 offset1:15
  v_pk_fma_f32 v[56:57], v[40:41], v[80:81], v[82:83]
  v_pk_fma_f32 v[58:59], v[42:43], v[84:85], v[86:87]
  v_pk_fma_f32 v[60:61], v[44:45], v[88:89], v[90:91]
  v_pk_fma_f32 v[62:63], v[46:47], v[92:93], v[94:95]
  v_pk_fma_f32 v[56:57], v[56:57], v[204:205], v[204:205] op_sel:[0,1,0] op_sel_hi:[1,1,0]
  v_pk_fma_f32 v[58:59], v[58:59], v[204:205], v[204:205] op_sel:[0,1,0] op_sel_hi:[1,1,0]
  v_pk_fma_f32 v[60:61], v[60:61], v[204:205], v[204:205] op_sel:[0,1,0] op_sel_hi:[1,1,0]
  v_pk_fma_f32 v[62:63], v[62:63], v[204:205], v[204:205] op_sel:[0,1,0] op_sel_hi:[1,1,0]
  v_cvt_pk_bf16_f32 v100, v56, v60
  v_cvt_pk_bf16_f32 v101, v57, v61
  v_cvt_pk_bf16_f32 v102, v58, v62
  v_cvt_pk_bf16_f32 v103, v59, v63
  ds_write2st64_b32 v189, v100, v101 offset0:2 offset1:7
  ds_write2st64_b32 v189, v102, v103 offset0:12 offset1:17
  ds_read_b64_tr_b16 v[128:129], v245 offset:32
  ds_read_b64_tr_b16 v[130:131], v245 offset:0
  ds_read_b64_tr_b16 v[136:137], v245 offset:544
  ds_read_b64_tr_b16 v[138:139], v245 offset:512
  ds_read_b64_tr_b16 v[144:145], v245 offset:1056
  ds_read_b64_tr_b16 v[146:147], v245 offset:1024
  ds_read_b64_tr_b16 v[152:153], v245 offset:1568
  ds_read_b64_tr_b16 v[154:155], v245 offset:1536
  ds_read_b64_tr_b16 v[160:161], v245 offset:2080
  ds_read_b64_tr_b16 v[162:163], v245 offset:2048
  ds_read_b64_tr_b16 v[168:169], v245 offset:2592
  ds_read_b64_tr_b16 v[170:171], v245 offset:2560
  ds_read_b64_tr_b16 v[176:177], v245 offset:3104
  ds_read_b64_tr_b16 v[178:179], v245 offset:3072
  ds_read_b64_tr_b16 v[184:185], v245 offset:3616
  ds_read_b64_tr_b16 v[186:187], v245 offset:3584
  s_waitcnt lgkmcnt(15)
  s_barrier
L_al1:
  ds_read2_b64 v[132:135], v246 offset0:8 offset1:9
  ds_read2_b64 v[140:143], v246 offset0:24 offset1:25
  ds_read2_b64 v[148:151], v246 offset0:40 offset1:41
  ds_read2_b64 v[156:159], v246 offset0:56 offset1:57
  s_waitcnt lgkmcnt(3)
  v_mfma_f32_16x16x32_bf16 v[192:195], v[128:131], v[132:135], 0
  ds_read2_b64 v[164:167], v246 offset0:72 offset1:73
  s_and_b32 s6, s2, 3
  s_waitcnt lgkmcnt(3)
  v_mfma_f32_16x16x32_bf16 v[196:199], v[128:131], v[140:143], 0
  ds_read2_b64 v[172:175], v246 offset0:88 offset1:89
  s_lshl_b32 s6, s6, 2
  v_mfma_f32_16x16x32_bf16 v[196:199], v[136:139], v[132:135], v[196:199]
  ds_read2_b64 v[180:183], v246 offset0:104 offset1:105
  s_lshr_b32 s7, s5, 3
  s_waitcnt lgkmcnt(4)
  v_mfma_f32_16x16x32_bf16 v[200:203], v[128:131], v[148:151], 0
  ds_read2_b64 v[188:191], v246 offset0:120 offset1:121
  s_add_u32 s84, s6, s7
  v_mfma_f32_16x16x32_bf16 v[200:203], v[136:139], v[140:143], v[200:203]
  ds_read_b64_tr_b16 v[64:65], v245 offset:288
  s_mul_i32 s6, s84, 7
  v_lshrrev_b32 v11, 1, v2
  v_mfma_f32_16x16x32_bf16 v[200:203], v[144:147], v[132:135], v[200:203]
  ds_read_b64_tr_b16 v[66:67], v245 offset:256
  v_min_u32 v11, 6, v11
  s_waitcnt lgkmcnt(6)
  v_mfma_f32_16x16x32_bf16 v[204:207], v[128:131], v[156:159], 0
  ds_read2_b64 v[68:71], v246 offset0:0 offset1:1
  v_add_u32 v11, s6, v11
  v_mfma_f32_16x16x32_bf16 v[204:207], v[136:139], v[148:151], v[204:207]
  ds_read_b64_tr_b16 v[72:73], v245 offset:800
  v_lshrrev_b32 v1, 2, v11
  v_mfma_f32_16x16x32_bf16 v[204:207], v[144:147], v[140:143], v[204:207]
  ds_read_b64_tr_b16 v[74:75], v245 offset:768
  v_mad_u32_u24 v1, v9, 28, v1
  v_mfma_f32_16x16x32_bf16 v[204:207], v[152:155], v[132:135], v[204:207]
  ds_read2_b64 v[76:79], v246 offset0:16 offset1:17
  v_lshlrev_b32 v24, 9, v1
  s_waitcnt lgkmcnt(9)
  v_mfma_f32_16x16x32_bf16 v[208:211], v[128:131], v[164:167], 0
  ds_read_b64_tr_b16 v[80:81], v245 offset:1312
  s_lshl_b32 s21, s3, 7
  v_mfma_f32_16x16x32_bf16 v[208:211], v[136:139], v[156:159], v[208:211]
  ds_read_b64_tr_b16 v[82:83], v245 offset:1280
  s_add_u32 s21, s21, 655360
  s_lshl_b32 s18, s3, 13
  v_mfma_f32_16x16x32_bf16 v[208:211], v[144:147], v[148:151], v[208:211]
  ds_read2_b64 v[84:87], v246 offset0:32 offset1:33
  s_mul_i32 s17, s84, 229376
  v_mfma_f32_16x16x32_bf16 v[208:211], v[152:155], v[140:143], v[208:211]
  ds_read_b64_tr_b16 v[88:89], v245 offset:1824
  s_add_u32 s17, s17, s18
  v_mfma_f32_16x16x32_bf16 v[208:211], v[160:163], v[132:135], v[208:211]
  ds_read_b64_tr_b16 v[90:91], v245 offset:1792
  s_add_u32 s17, s17, 5373952
  s_waitcnt lgkmcnt(13)
  v_mfma_f32_16x16x32_bf16 v[212:215], v[128:131], v[172:175], 0
  ds_read2_b64 v[92:95], v246 offset0:48 offset1:49
  s_lshr_b32 s6, s3, 1
  v_mfma_f32_16x16x32_bf16 v[212:215], v[136:139], v[164:167], v[212:215]
  s_waitcnt vmcnt(0)
  v_cmp_ne_u32 vcc, s50, v255
  ds_read_b64_tr_b16 v[96:97], v245 offset:2336
  v_mfma_f32_16x16x32_bf16 v[212:215], v[144:147], v[156:159], v[212:215]
  ds_read_b64_tr_b16 v[98:99], v245 offset:2304
  s_mul_i32 s6, s6, 18704
  v_mfma_f32_16x16x32_bf16 v[212:215], v[152:155], v[148:151], v[212:215]
L_b2a:
  s_cbranch_vccnz L_r2a
L_o2a:
  v_mfma_f32_16x16x32_bf16 v[212:215], v[160:163], v[140:143], v[212:215]
  buffer_load_dwordx4 a[0:3], v23, s[8:11], s48 offen offset:0 sc1
  ds_read2_b64 v[100:103], v246 offset0:64 offset1:65
  v_mfma_f32_16x16x32_bf16 v[212:215], v[168:171], v[132:135], v[212:215]
  ds_read_b64_tr_b16 v[104:105], v245 offset:2848
  s_mul_i32 s7, s83, 9248
  s_waitcnt lgkmcnt(15)
  v_mfma_f32_16x16x32_bf16 v[216:219], v[128:131], v[180:183], 0
  ds_read_b64_tr_b16 v[106:107], v245 offset:2816
  s_add_u32 s6, s6, s7
  v_mfma_f32_16x16x32_bf16 v[216:219], v[136:139], v[172:175], v[216:219]
  ds_read2_b64 v[108:111], v246 offset0:80 offset1:81
  s_add_u32 s6, s6, 125184
  v_and_b32 v1, 7, v2
  v_mfma_f32_16x16x32_bf16 v[216:219], v[144:147], v[164:167], v[216:219]
  buffer_load_dwordx4 a[4:7], v23, s[8:11], s48 offen offset:512 sc1
  v_mfma_f32_16x16x32_bf16 v[216:219], v[152:155], v[156:159], v[216:219]
  ds_read_b64_tr_b16 v[112:113], v245 offset:3360
  v_lshl_add_u32 v1, v1, 2, s6
  v_mfma_f32_16x16x32_bf16 v[216:219], v[160:163], v[148:151], v[216:219]
  ds_read_b64_tr_b16 v[114:115], v245 offset:3328
  ds_write_b32 v1, v252
  v_mfma_f32_16x16x32_bf16 v[216:219], v[168:171], v[140:143], v[216:219]
  ds_read2_b64 v[116:119], v246 offset0:96 offset1:97
  s_add_u32 s6, s6, 32
  v_lshrrev_b32 v11, 1, v26
  v_mfma_f32_16x16x32_bf16 v[216:219], v[176:179], v[132:135], v[216:219]
  buffer_load_dwordx4 a[8:11], v23, s[8:11], s48 offen offset:1024 sc1
  v_mfma_f32_16x16x32_bf16 v[220:223], v[128:131], v[188:191], 0
  ds_read_b64_tr_b16 v[120:121], v245 offset:3872
  v_add_lshl_u32 v11, v11, v27, 4
  v_mfma_f32_16x16x32_bf16 v[220:223], v[136:139], v[180:183], v[220:223]
  ds_read_b64_tr_b16 v[122:123], v245 offset:3840
  v_lshl_add_u32 v11, v26, 6, v11
  v_mfma_f32_16x16x32_bf16 v[220:223], v[144:147], v[172:175], v[220:223]
  ds_read2_b64 v[124:127], v246 offset0:112 offset1:113
  v_add_u32 v25, s6, v11
  v_mfma_f32_16x16x32_bf16 v[220:223], v[152:155], v[164:167], v[220:223]
  buffer_load_dwordx4 a[12:15], v23, s[8:11], s48 offen offset:1536 sc1
  v_mfma_f32_16x16x32_bf16 v[220:223], v[160:163], v[156:159], v[220:223]
  v_lshlrev_b32 v31, 7, v0
  v_mfma_f32_16x16x32_bf16 v[220:223], v[168:171], v[148:151], v[220:223]
  s_mov_b32 s22, 655360
  v_mfma_f32_16x16x32_bf16 v[220:223], v[176:179], v[140:143], v[220:223]
  v_mfma_f32_16x16x32_bf16 v[220:223], v[184:187], v[132:135], v[220:223]
  buffer_load_dwordx4 a[16:19], v23, s[8:11], s49 offen offset:0 sc1
  s_waitcnt lgkmcnt(0)
  v_mfma_f32_16x16x32_bf16 v[192:195], v[64:67], v[68:71], v[192:195]
  ds_read_b64_tr_b16 v[128:129], v245 offset:4192
  s_sub_u32 s23, s65, 622592
  v_lshrrev_b32 v11, 3, v0
  v_mfma_f32_16x16x32_bf16 v[196:199], v[64:67], v[76:79], v[196:199]
  ds_read_b64_tr_b16 v[130:131], v245 offset:4160
  v_lshlrev_b32 v11, 4, v11
  v_mfma_f32_16x16x32_bf16 v[196:199], v[72:75], v[68:71], v[196:199]
  ds_read2_b64 v[132:135], v17 offset0:8 offset1:9
  v_lshl_add_u32 v11, v10, 5, v11
  v_mfma_f32_16x16x32_bf16 v[200:203], v[64:67], v[84:87], v[200:203]
  buffer_load_dwordx4 a[20:23], v23, s[8:11], s49 offen offset:512 sc1
  v_mfma_f32_16x16x32_bf16 v[200:203], v[72:75], v[76:79], v[200:203]
  s_barrier
  s_mov_b32 exec_hi, 0
  buffer_store_dword v19, v18, s[8:11], s65 offen sc1
  s_mov_b32 exec_hi, -1
  ds_read_b64_tr_b16 v[136:137], v245 offset:4704
  v_mfma_f32_16x16x32_bf16 v[200:203], v[80:83], v[68:71], v[200:203]
  ds_read_b64_tr_b16 v[138:139], v245 offset:4672
  v_mul_u32_u24 v1, 18704, v9
  v_mfma_f32_16x16x32_bf16 v[204:207], v[64:67], v[92:95], v[204:207]
  ds_read2_b64 v[140:143], v17 offset0:24 offset1:25
  s_mov_b32 s6, 125216
  v_add3_u32 v30, v11, v1, s6
  v_mfma_f32_16x16x32_bf16 v[204:207], v[72:75], v[84:87], v[204:207]
  buffer_load_dwordx4 a[24:27], v23, s[8:11], s49 offen offset:1024 sc1
  v_mfma_f32_16x16x32_bf16 v[204:207], v[80:83], v[76:79], v[204:207]
  ds_read_b64_tr_b16 v[144:145], v245 offset:5216
  v_and_b32 v1, 3, v10
  v_mfma_f32_16x16x32_bf16 v[204:207], v[88:91], v[68:71], v[204:207]
  ds_read_b64_tr_b16 v[146:147], v245 offset:5184
  v_min_u32 v1, 1, v1
  v_mfma_f32_16x16x32_bf16 v[208:211], v[64:67], v[100:103], v[208:211]
  ds_read2_b64 v[148:151], v17 offset0:40 offset1:41
  v_lshl_add_u32 v1, v1, 4, v30
  v_mfma_f32_16x16x32_bf16 v[208:211], v[72:75], v[92:95], v[208:211]
  buffer_load_dwordx4 a[28:31], v23, s[8:11], s49 offen offset:1536 sc1
  v_mfma_f32_16x16x32_bf16 v[208:211], v[80:83], v[84:87], v[208:211]
  ds_read_b64_tr_b16 v[152:153], v245 offset:5728
  v_subrev_u32 v244, 20, v1
  v_mfma_f32_16x16x32_bf16 v[208:211], v[88:91], v[76:79], v[208:211]
  ds_read_b64_tr_b16 v[154:155], v245 offset:5696
  v_fmac_f32 v32, v253, v48
  v_mfma_f32_16x16x32_bf16 v[208:211], v[96:99], v[68:71], v[208:211]
  ds_read2_b64 v[156:159], v17 offset0:56 offset1:57
  v_fmac_f32 v33, v253, v49
  v_mfma_f32_16x16x32_bf16 v[212:215], v[64:67], v[108:111], v[212:215]
  buffer_load_dwordx4 a[32:35], v23, s[8:11], s48 offen offset:2048 sc1
  v_mfma_f32_16x16x32_bf16 v[212:215], v[72:75], v[100:103], v[212:215]
  ds_read_b64_tr_b16 v[160:161], v245 offset:6240
  v_fmac_f32 v34, v253, v50
  v_mfma_f32_16x16x32_bf16 v[212:215], v[80:83], v[92:95], v[212:215]
  ds_read_b64_tr_b16 v[162:163], v245 offset:6208
  v_fmac_f32 v35, v253, v51
  v_mfma_f32_16x16x32_bf16 v[212:215], v[88:91], v[84:87], v[212:215]
  ds_read2_b64 v[164:167], v17 offset0:72 offset1:73
  v_fmac_f32 v36, v253, v52
  v_mfma_f32_16x16x32_bf16 v[212:215], v[96:99], v[76:79], v[212:215]
  buffer_load_dwordx4 a[36:39], v23, s[8:11], s48 offen offset:2560 sc1
  v_mfma_f32_16x16x32_bf16 v[212:215], v[104:107], v[68:71], v[212:215]
  ds_read_b64_tr_b16 v[168:169], v245 offset:6752
  v_fmac_f32 v37, v253, v53
  v_mfma_f32_16x16x32_bf16 v[216:219], v[64:67], v[116:119], v[216:219]
  ds_read_b64_tr_b16 v[170:171], v245 offset:6720
  v_fmac_f32 v38, v253, v54
  v_mfma_f32_16x16x32_bf16 v[216:219], v[72:75], v[108:111], v[216:219]
  ds_read2_b64 v[172:175], v17 offset0:88 offset1:89
  v_fmac_f32 v39, v253, v55
  v_mfma_f32_16x16x32_bf16 v[216:219], v[80:83], v[100:103], v[216:219]
  buffer_load_dwordx4 a[40:43], v23, s[8:11], s48 offen offset:3072 sc1
  v_mfma_f32_16x16x32_bf16 v[216:219], v[88:91], v[92:95], v[216:219]
  ds_read_b64_tr_b16 v[176:177], v245 offset:7264
  v_fmac_f32 v40, v253, v56
  v_mfma_f32_16x16x32_bf16 v[216:219], v[96:99], v[84:87], v[216:219]
  ds_read_b64_tr_b16 v[178:179], v245 offset:7232
  v_fmac_f32 v41, v253, v57
  v_mfma_f32_16x16x32_bf16 v[216:219], v[104:107], v[76:79], v[216:219]
  ds_read2_b64 v[180:183], v17 offset0:104 offset1:105
  v_fmac_f32 v42, v253, v58
  v_mfma_f32_16x16x32_bf16 v[216:219], v[112:115], v[68:71], v[216:219]
  buffer_load_dwordx4 a[44:47], v23, s[8:11], s48 offen offset:3584 sc1
  v_mfma_f32_16x16x32_bf16 v[220:223], v[64:67], v[124:127], v[220:223]
  ds_read_b64_tr_b16 v[184:185], v245 offset:7776
  v_fmac_f32 v43, v253, v59
  v_mfma_f32_16x16x32_bf16 v[220:223], v[72:75], v[116:119], v[220:223]
  ds_read_b64_tr_b16 v[186:187], v245 offset:7744
  v_fmac_f32 v44, v253, v60
  v_mfma_f32_16x16x32_bf16 v[220:223], v[80:83], v[108:111], v[220:223]
  ds_read2_b64 v[188:191], v17 offset0:120 offset1:121
  v_fmac_f32 v45, v253, v61
  v_mfma_f32_16x16x32_bf16 v[220:223], v[88:91], v[100:103], v[220:223]
  buffer_load_dwordx4 a[48:51], v23, s[8:11], s49 offen offset:2048 sc1
  v_mfma_f32_16x16x32_bf16 v[220:223], v[96:99], v[92:95], v[220:223]
  v_fmac_f32 v46, v253, v62
  v_mfma_f32_16x16x32_bf16 v[220:223], v[104:107], v[84:87], v[220:223]
  v_fmac_f32 v47, v253, v63
  v_mfma_f32_16x16x32_bf16 v[220:223], v[112:115], v[76:79], v[220:223]
  v_mfma_f32_16x16x32_bf16 v[220:223], v[120:123], v[68:71], v[220:223]
  buffer_load_dwordx4 a[52:55], v23, s[8:11], s49 offen offset:2560 sc1
  s_waitcnt lgkmcnt(0)
  v_mfma_f32_16x16x32_bf16 v[192:195], v[128:131], v[132:135], v[192:195]
  ds_read_b64_tr_b16 v[64:65], v245 offset:4448
  s_bfe_u32 s6, s2, 0x10002
  v_mfma_f32_16x16x32_bf16 v[196:199], v[128:131], v[140:143], v[196:199]
  ds_read_b64_tr_b16 v[66:67], v245 offset:4416
  s_lshl_b32 s6, s6, 3
  v_mfma_f32_16x16x32_bf16 v[196:199], v[136:139], v[132:135], v[196:199]
  ds_read2_b64 v[68:71], v17 offset0:0 offset1:1
  s_and_b32 s7, s5, 7
  v_mfma_f32_16x16x32_bf16 v[200:203], v[128:131], v[148:151], v[200:203]
  buffer_load_dwordx4 a[56:59], v23, s[8:11], s49 offen offset:3072 sc1
  v_mfma_f32_16x16x32_bf16 v[200:203], v[136:139], v[140:143], v[200:203]
  ds_read_b64_tr_b16 v[72:73], v245 offset:4960
  s_add_u32 s6, s6, s7
  v_mfma_f32_16x16x32_bf16 v[200:203], v[144:147], v[132:135], v[200:203]
  ds_read_b64_tr_b16 v[74:75], v245 offset:4928
  s_lshl_b32 s6, s6, 2
  v_mfma_f32_16x16x32_bf16 v[204:207], v[128:131], v[156:159], v[204:207]
  ds_read2_b64 v[76:79], v17 offset0:16 offset1:17
  s_add_u32 s85, s6, s3
  v_mfma_f32_16x16x32_bf16 v[204:207], v[136:139], v[148:151], v[204:207]
  buffer_load_dwordx4 a[60:63], v23, s[8:11], s49 offen offset:3584 sc1
  v_mfma_f32_16x16x32_bf16 v[204:207], v[144:147], v[140:143], v[204:207]
  ds_read_b64_tr_b16 v[80:81], v245 offset:5472
  s_lshl_b32 s16, s85, 15
  v_mfma_f32_16x16x32_bf16 v[204:207], v[152:155], v[132:135], v[204:207]
  ds_read_b64_tr_b16 v[82:83], v245 offset:5440
  s_add_u32 s16, s16, 3276800
  v_mfma_f32_16x16x32_bf16 v[208:211], v[128:131], v[164:167], v[208:211]
  ds_read2_b64 v[84:87], v17 offset0:32 offset1:33
  s_mov_b32 s20, s16
  v_and_b32 v11, 32, v2
  v_mfma_f32_16x16x32_bf16 v[208:211], v[136:139], v[156:159], v[208:211]
  s_add_u32 s48, s48, 4096
  buffer_load_dwordx4 a[64:67], v23, s[8:11], s48 offen offset:0 sc1
  v_mfma_f32_16x16x32_bf16 v[208:211], v[144:147], v[148:151], v[208:211]
  ds_read_b64_tr_b16 v[88:89], v245 offset:5984
  v_xor_b32 v12, v3, v11
  v_mfma_f32_16x16x32_bf16 v[208:211], v[152:155], v[140:143], v[208:211]
  ds_read_b64_tr_b16 v[90:91], v245 offset:5952
  v_mfma_f32_16x16x32_bf16 v[208:211], v[160:163], v[132:135], v[208:211]
  ds_read2_b64 v[92:95], v17 offset0:48 offset1:49
  v_mfma_f32_16x16x32_bf16 v[212:215], v[128:131], v[172:175], v[212:215]
  buffer_load_dwordx4 a[68:71], v23, s[8:11], s48 offen offset:512 sc1
  v_mfma_f32_16x16x32_bf16 v[212:215], v[136:139], v[164:167], v[212:215]
  ds_read_b64_tr_b16 v[96:97], v245 offset:6496
  v_mfma_f32_16x16x32_bf16 v[212:215], v[144:147], v[156:159], v[212:215]
  ds_read_b64_tr_b16 v[98:99], v245 offset:6464
  v_mfma_f32_16x16x32_bf16 v[212:215], v[152:155], v[148:151], v[212:215]
  ds_read2_b64 v[100:103], v17 offset0:64 offset1:65
  v_mfma_f32_16x16x32_bf16 v[212:215], v[160:163], v[140:143], v[212:215]
  buffer_load_dwordx4 a[72:75], v23, s[8:11], s48 offen offset:1024 sc1
  v_mfma_f32_16x16x32_bf16 v[212:215], v[168:171], v[132:135], v[212:215]
  ds_read_b64_tr_b16 v[104:105], v245 offset:7008
  v_mfma_f32_16x16x32_bf16 v[216:219], v[128:131], v[180:183], v[216:219]
  ds_read_b64_tr_b16 v[106:107], v245 offset:6976
  v_mfma_f32_16x16x32_bf16 v[216:219], v[136:139], v[172:175], v[216:219]
  ds_read2_b64 v[108:111], v17 offset0:80 offset1:81
  v_mfma_f32_16x16x32_bf16 v[216:219], v[144:147], v[164:167], v[216:219]
  buffer_load_dwordx4 a[76:79], v23, s[8:11], s48 offen offset:1536 sc1
  v_mfma_f32_16x16x32_bf16 v[216:219], v[152:155], v[156:159], v[216:219]
  ds_read_b64_tr_b16 v[112:113], v245 offset:7520
  v_mfma_f32_16x16x32_bf16 v[216:219], v[160:163], v[148:151], v[216:219]
  ds_read_b64_tr_b16 v[114:115], v245 offset:7488
  v_mfma_f32_16x16x32_bf16 v[216:219], v[168:171], v[140:143], v[216:219]
  ds_read2_b64 v[116:119], v17 offset0:96 offset1:97
  v_mfma_f32_16x16x32_bf16 v[216:219], v[176:179], v[132:135], v[216:219]
  s_add_u32 s49, s49, 4096
  buffer_load_dwordx4 a[80:83], v23, s[8:11], s49 offen offset:0 sc1
  v_mfma_f32_16x16x32_bf16 v[220:223], v[128:131], v[188:191], v[220:223]
  ds_read_b64_tr_b16 v[120:121], v245 offset:8032
  v_mfma_f32_16x16x32_bf16 v[220:223], v[136:139], v[180:183], v[220:223]
  ds_read_b64_tr_b16 v[122:123], v245 offset:8000
  v_mfma_f32_16x16x32_bf16 v[220:223], v[144:147], v[172:175], v[220:223]
  ds_read2_b64 v[124:127], v17 offset0:112 offset1:113
  v_mfma_f32_16x16x32_bf16 v[220:223], v[152:155], v[164:167], v[220:223]
  buffer_load_dwordx4 a[84:87], v23, s[8:11], s49 offen offset:512 sc1
  v_mfma_f32_16x16x32_bf16 v[220:223], v[160:163], v[156:159], v[220:223]
  v_mfma_f32_16x16x32_bf16 v[220:223], v[168:171], v[148:151], v[220:223]
  v_mfma_f32_16x16x32_bf16 v[220:223], v[176:179], v[140:143], v[220:223]
  v_mfma_f32_16x16x32_bf16 v[220:223], v[184:187], v[132:135], v[220:223]
  buffer_load_dwordx4 a[88:91], v23, s[8:11], s49 offen offset:1024 sc1
  s_waitcnt lgkmcnt(0)
  v_mfma_f32_16x16x32_bf16 v[192:195], v[64:67], v[68:71], v[192:195]
  v_mfma_f32_16x16x32_bf16 v[196:199], v[64:67], v[76:79], v[196:199]
  v_mfma_f32_16x16x32_bf16 v[196:199], v[72:75], v[68:71], v[196:199]
  v_mfma_f32_16x16x32_bf16 v[200:203], v[64:67], v[84:87], v[200:203]
  buffer_load_dwordx4 a[92:95], v23, s[8:11], s49 offen offset:1536 sc1
  v_mfma_f32_16x16x32_bf16 v[200:203], v[72:75], v[76:79], v[200:203]
  v_mfma_f32_16x16x32_bf16 v[200:203], v[80:83], v[68:71], v[200:203]
  s_nop 1
  ds_write_b128 v25, v[192:195] offset:0
  v_mfma_f32_16x16x32_bf16 v[204:207], v[64:67], v[92:95], v[204:207]
  v_mfma_f32_16x16x32_bf16 v[204:207], v[72:75], v[84:87], v[204:207]
  buffer_load_dwordx4 a[96:99], v23, s[8:11], s48 offen offset:2048 sc1
  v_mfma_f32_16x16x32_bf16 v[204:207], v[80:83], v[76:79], v[204:207]
  ds_write_b128 v25, v[196:199] offset:1152
  v_mfma_f32_16x16x32_bf16 v[204:207], v[88:91], v[68:71], v[204:207]
  v_mfma_f32_16x16x32_bf16 v[208:211], v[64:67], v[100:103], v[208:211]
  ds_write_b128 v25, v[200:203] offset:2304
  v_mfma_f32_16x16x32_bf16 v[208:211], v[72:75], v[92:95], v[208:211]
  buffer_load_dwordx4 a[100:103], v23, s[8:11], s48 offen offset:2560 sc1
  v_mfma_f32_16x16x32_bf16 v[208:211], v[80:83], v[84:87], v[208:211]
  v_mfma_f32_16x16x32_bf16 v[208:211], v[88:91], v[76:79], v[208:211]
  v_mfma_f32_16x16x32_bf16 v[208:211], v[96:99], v[68:71], v[208:211]
  s_nop 0
  ds_write_b128 v25, v[204:207] offset:3456
  v_mfma_f32_16x16x32_bf16 v[212:215], v[64:67], v[108:111], v[212:215]
  buffer_load_dwordx4 a[104:107], v23, s[8:11], s48 offen offset:3072 sc1
  v_mfma_f32_16x16x32_bf16 v[212:215], v[72:75], v[100:103], v[212:215]
  v_mfma_f32_16x16x32_bf16 v[212:215], v[80:83], v[92:95], v[212:215]
  v_mfma_f32_16x16x32_bf16 v[212:215], v[88:91], v[84:87], v[212:215]
  v_mfma_f32_16x16x32_bf16 v[212:215], v[96:99], v[76:79], v[212:215]
  buffer_load_dwordx4 a[108:111], v23, s[8:11], s48 offen offset:3584 sc1
  v_mfma_f32_16x16x32_bf16 v[212:215], v[104:107], v[68:71], v[212:215]
  ds_write_b128 v25, v[208:211] offset:4608
  v_mfma_f32_16x16x32_bf16 v[216:219], v[64:67], v[116:119], v[216:219]
  v_mfma_f32_16x16x32_bf16 v[216:219], v[72:75], v[108:111], v[216:219]
  v_mfma_f32_16x16x32_bf16 v[216:219], v[80:83], v[100:103], v[216:219]
  buffer_load_dwordx4 a[112:115], v23, s[8:11], s49 offen offset:2048 sc1
  v_mfma_f32_16x16x32_bf16 v[216:219], v[88:91], v[92:95], v[216:219]
  v_mfma_f32_16x16x32_bf16 v[216:219], v[96:99], v[84:87], v[216:219]
  s_nop 0
  ds_write_b128 v25, v[212:215] offset:5760
  v_mfma_f32_16x16x32_bf16 v[216:219], v[104:107], v[76:79], v[216:219]
  v_mfma_f32_16x16x32_bf16 v[216:219], v[112:115], v[68:71], v[216:219]
  buffer_load_dwordx4 a[116:119], v23, s[8:11], s49 offen offset:2560 sc1
  v_mfma_f32_16x16x32_bf16 v[220:223], v[64:67], v[124:127], v[220:223]
  v_mfma_f32_16x16x32_bf16 v[220:223], v[72:75], v[116:119], v[220:223]
  v_mfma_f32_16x16x32_bf16 v[220:223], v[80:83], v[108:111], v[220:223]
  v_mfma_f32_16x16x32_bf16 v[220:223], v[88:91], v[100:103], v[220:223]
  v_mfma_f32_16x16x32_bf16 v[220:223], v[96:99], v[92:95], v[220:223]
  s_nop 1
  ds_write_b128 v25, v[216:219] offset:6912
  v_mfma_f32_16x16x32_bf16 v[220:223], v[104:107], v[84:87], v[220:223]
  v_mfma_f32_16x16x32_bf16 v[220:223], v[112:115], v[76:79], v[220:223]
  v_mfma_f32_16x16x32_bf16 v[220:223], v[120:123], v[68:71], v[220:223]
  buffer_load_dword v224, v31, s[8:11], s22 offen sc1
  buffer_load_dword v255, v24, s[8:11], s21 offen sc1
  s_nop 5
  ds_write_b128 v25, v[220:223] offset:8064
  s_waitcnt lgkmcnt(0)
  s_barrier
  ds_read_b128 v[128:131], v30 offset:0
  ds_read_b128 v[132:135], v30 offset:16
  ds_read_b32 v139, v244 offset:9248
  ds_read_b128 v[140:143], v30 offset:9248
  ds_read_b128 v[144:147], v30 offset:9264
  ds_read_b128 v[148:151], v30 offset:4608
  ds_read_b128 v[152:155], v30 offset:4624
  ds_read_b32 v159, v244 offset:13856
  ds_read_b128 v[160:163], v30 offset:13856
  ds_read_b128 v[164:167], v30 offset:13872
  s_waitcnt lgkmcnt(8)
  v_pk_fma_f32 v[32:33], v[128:129], v[230:231], v[32:33] op_sel:[0,0,0] op_sel_hi:[1,0,1]
  v_pk_fma_f32 v[34:35], v[130:131], v[230:231], v[34:35] op_sel:[0,0,0] op_sel_hi:[1,0,1]
  v_pk_fma_f32 v[36:37], v[132:133], v[230:231], v[36:37] op_sel:[0,0,0] op_sel_hi:[1,0,1]
  v_pk_fma_f32 v[38:39], v[134:135], v[230:231], v[38:39] op_sel:[0,0,0] op_sel_hi:[1,0,1]
  s_waitcnt lgkmcnt(5)
  v_fmac_f32 v32, v230, v139
  v_fmac_f32 v33, v230, v140
  v_fmac_f32 v34, v230, v141
  v_fmac_f32 v35, v230, v142
  v_fmac_f32 v36, v230, v143
  v_fmac_f32 v37, v230, v144
  v_fmac_f32 v38, v230, v145
  v_fmac_f32 v39, v230, v146
  v_cvt_pk_bf16_f32 v48, v32, v33
  v_cvt_pk_bf16_f32 v49, v34, v35
  v_cvt_pk_bf16_f32 v50, v36, v37
  v_cvt_pk_bf16_f32 v51, v38, v39
  buffer_store_dwordx4 v[48:51], v254, s[8:11], s78 offen sc1
  s_waitcnt lgkmcnt(3)
  v_pk_fma_f32 v[40:41], v[148:149], v[230:231], v[40:41] op_sel:[0,0,0] op_sel_hi:[1,0,1]
  v_pk_fma_f32 v[42:43], v[150:151], v[230:231], v[42:43] op_sel:[0,0,0] op_sel_hi:[1,0,1]
  v_pk_fma_f32 v[44:45], v[152:153], v[230:231], v[44:45] op_sel:[0,0,0] op_sel_hi:[1,0,1]
  v_pk_fma_f32 v[46:47], v[154:155], v[230:231], v[46:47] op_sel:[0,0,0] op_sel_hi:[1,0,1]
  s_waitcnt lgkmcnt(0)
  v_fmac_f32 v40, v230, v159
  v_fmac_f32 v41, v230, v160
  v_fmac_f32 v42, v230, v161
  v_fmac_f32 v43, v230, v162
  v_fmac_f32 v44, v230, v163
  v_fmac_f32 v45, v230, v164
  v_fmac_f32 v46, v230, v165
  v_fmac_f32 v47, v230, v166
  v_cvt_pk_bf16_f32 v52, v40, v41
  v_cvt_pk_bf16_f32 v53, v42, v43
  v_cvt_pk_bf16_f32 v54, v44, v45
  v_cvt_pk_bf16_f32 v55, v46, v47
  buffer_store_dwordx4 v[52:55], v254, s[8:11], s79 offen sc1
  s_waitcnt vmcnt(2)
L_call:
  v_min3_u32 v1, v224, v255, s50
  v_max3_u32 v11, v224, v255, s50
  v_cmp_ne_u32 vcc, v1, v11
  s_nop 0
  s_cbranch_vccnz L_rall
L_oall:
  s_add_u32 m0, s18, 0
  s_nop 0
  buffer_load_dwordx4 v3, s[8:11], s17 offen offset:0 sc1 lds
  buffer_load_dwordx4 v3, s[8:11], s17 offen offset:1024 sc1 lds
  buffer_load_dwordx4 v3, s[8:11], s17 offen offset:2048 sc1 lds
  buffer_load_dwordx4 v3, s[8:11], s17 offen offset:3072 sc1 lds
  s_add_u32 m0, s18, 4096
  s_add_u32 s17, s17, 4096
  buffer_load_dwordx4 v3, s[8:11], s17 offen offset:0 sc1 lds
  buffer_load_dwordx4 v3, s[8:11], s17 offen offset:1024 sc1 lds
  buffer_load_dwordx4 v3, s[8:11], s17 offen offset:2048 sc1 lds
  buffer_load_dwordx4 v3, s[8:11], s17 offen offset:3072 sc1 lds
  s_add_u32 m0, s18, 32768
  s_add_u32 s17, s17, 28672
  buffer_load_dwordx4 v3, s[8:11], s17 offen offset:0 sc1 lds
  buffer_load_dwordx4 v3, s[8:11], s17 offen offset:1024 sc1 lds
  buffer_load_dwordx4 v3, s[8:11], s17 offen offset:2048 sc1 lds
  buffer_load_dwordx4 v3, s[8:11], s17 offen offset:3072 sc1 lds
  s_add_u32 m0, s18, 36864
  s_add_u32 s17, s17, 4096
  buffer_load_dwordx4 v3, s[8:11], s17 offen offset:0 sc1 lds
  buffer_load_dwordx4 v3, s[8:11], s17 offen offset:1024 sc1 lds
  buffer_load_dwordx4 v3, s[8:11], s17 offen offset:2048 sc1 lds
  buffer_load_dwordx4 v3, s[8:11], s17 offen offset:3072 sc1 lds
  s_getpc_b64 s[60:61]
L_pc2:
  s_mov_b32 s62, L_stubs-L_pc2
  s_mov_b32 s63, 0x20000
  s_and_b32 s24, s5, 15
  s_lshl_b32 s24, s24, 2
  s_add_u32 s24, s24, s3
  s_lshl_b32 s24, s24, 7
  v_lshlrev_b32 v31, 13, v2
  s_mov_b64 exec, 0x7
  buffer_load_dword v30, v31, s[60:63], s24 offen
  s_mov_b64 exec, -1
  s_or_b32 s6, s2, s3
  s_cmp_lg_u32 s6, 0
  s_cselect_b32 s6, 0x7f000000, 0
  v_lshlrev_b32 v10, 2, v2
  s_mov_b32 exec_hi, 0
  buffer_store_dword v19, v10, s[8:11], s6 offen sc1
  s_mov_b32 exec_hi, -1
  s_mul_i32 s19, s3, 28672
  s_mul_i32 s7, s84, 1792
  s_add_u32 s19, s19, s7
  s_add_u32 s19, s19, 131072
  v_lshlrev_b32 v13, 9, v27
  v_lshl_add_u32 v13, v29, 6, v13
  v_lshl_add_u32 v13, v28, 3, v13
  v_and_b32 v11, 1, v27
  v_lshl_add_u32 v13, v11, 5, v13
  s_add_u32 s7, s18, 98304
  v_add_u32 v13, s7, v13
  v_xor_b32 v14, 32, v13
  v_add_u32 v15, 65536, v3
  v_lshl_add_u32 v16, v27, 13, v247
  v_add_u32 v16, 131072, v16
  s_lshl_b32 s6, s85, 4
  s_add_u32 s6, s6, s84
  s_mul_i32 s44, s6, 7168
  s_add_u32 s44, s44, 10878976
  s_add_u32 s45, s44, 4096
  s_lshl_b32 s29, s6, 7
  s_add_u32 s29, s29, 786432
  v_mov_b64 v[106:107], 0
  v_mov_b64 v[110:111], 0
  v_mov_b32 v96, s33
  v_accvgpr_write_b32 a232, -1
  v_mov_b32 v97, s33
  v_accvgpr_write_b32 a233, -1
  v_mov_b32 v98, s33
  v_accvgpr_write_b32 a234, -1
  v_mov_b32 v99, s33
  v_accvgpr_write_b32 a235, -1
  v_cmp_eq_u32 s[54:55], v27, v29
  v_cmp_lt_u32 s[56:57], 1, v28
  s_bfe_u32 s6, s2, 0x20001
  s_lshl_b32 s6, s6, 3
  s_and_b32 s7, s5, 7
  s_add_u32 s25, s6, s7
  s_lshl_b32 s6, s25, 3
  s_add_u32 s6, s6, s3
  s_mul_i32 s40, s6, 28672
  s_add_u32 s40, s40, 10878976
  s_add_u32 s41, s40, 4096
  s_add_u32 s42, s40, 14336
  s_add_u32 s43, s40, 18432
  s_lshl_b32 s30, s6, 9
  s_add_u32 s30, s30, 786432
  v_bfe_u32 v1, v2, 2, 1
  v_lshlrev_b32 v1, 11, v1
  v_lshl_add_u32 v8, v28, 7, v1
  v_lshrrev_b32 v1, 1, v27
  v_mul_u32_u24 v1, 7168, v1
  v_lshl_add_u32 v1, v11, 9, v1
  v_lshl_add_u32 v1, v26, 4, v1
  s_lshl_b32 s7, s83, 8
  v_add_u32 v1, s7, v1
  s_lshr_b32 s6, s3, 1
  s_mul_i32 s7, s6, 114688
  v_add_u32 v4, s7, v1
  s_sub_u32 s7, 114688, s7
  v_add_u32 v6, s7, v1
  v_xor_b32 v5, 256, v4
  v_xor_b32 v7, 256, v6
  s_lshl_b32 s27, s25, 1
  s_add_u32 s27, s27, s6
  s_lshl_b32 s27, s27, 3
  s_add_u32 s27, s27, s77
  s_lshl_b32 s27, s27, 7
  s_add_u32 s27, s27, s83
  s_lshl_b32 s27, s27, 5
  s_add_u32 s27, s27, 3276800
  v_lshrrev_b32 v24, 1, v2
  v_lshlrev_b32 v24, 6, v24
  v_lshl_add_u32 v24, v9, 4, v24
  s_add_u32 s7, s18, 133120
  v_lshl_add_u32 v1, v26, 7, s7
  v_lshl_add_u32 v0, v27, 3, v1
  s_add_u32 s23, s27, 1024
  s_waitcnt vmcnt(18)
  s_barrier
  s_add_u32 m0, s18, 131072
  s_nop 0
  buffer_load_dwordx4 v12, s[8:11], s16 offen offset:0 sc1 lds
  buffer_load_dwordx4 v12, s[8:11], s16 offen offset:1024 sc1 lds
  buffer_load_dwordx4 v12, s[8:11], s16 offen offset:2048 sc1 lds
  buffer_load_dwordx4 v12, s[8:11], s16 offen offset:3072 sc1 lds
  s_add_u32 m0, s18, 135168
  s_add_u32 s16, s16, 4096
  buffer_load_dwordx4 v12, s[8:11], s16 offen offset:0 sc1 lds
  buffer_load_dwordx4 v12, s[8:11], s16 offen offset:1024 sc1 lds
  buffer_load_dwordx4 v12, s[8:11], s16 offen offset:2048 sc1 lds
  buffer_load_dwordx4 v12, s[8:11], s16 offen offset:3072 sc1 lds
  s_add_u32 m0, s18, 98304
  s_add_u32 s16, s16, 4096
  buffer_load_dwordx4 v12, s[8:11], s16 offen offset:0 sc1 lds
  buffer_load_dwordx4 v12, s[8:11], s16 offen offset:1024 sc1 lds
  s_xor_b32 s7, s3, 1
  s_mul_i32 s7, s7, 12288
  s_add_u32 s7, s7, 0
  v_add_u32 v17, s7, v3
  s_xor_b32 s7, s3, 2
  s_mul_i32 s7, s7, 12288
  s_add_u32 s7, s7, 4096
  v_add_u32 v18, s7, v3
  s_xor_b32 s7, s3, 3
  s_mul_i32 s7, s7, 12288
  s_add_u32 s7, s7, 8192
  v_add_u32 v20, s7, v3
  s_mul_i32 s7, s3, 12288
  v_add_u32 v21, s7, v3
  v_lshl_add_u32 v22, v27, 12, v247
  s_lshl_b32 s26, s25, 2
  s_add_u32 s26, s26, s3
  s_lshl_b32 s26, s26, 7
  s_add_u32 s26, s26, s77
  s_lshl_b32 s26, s26, 7
  v_mul_u32_u24 v25, 24576, v27
  v_lshl_add_u32 v25, v26, 5, v25
  s_lshl_b32 s28, s77, 9
  s_add_u32 s28, s28, 544768
  s_and_b32 s7, s77, 3
  s_mul_i32 s7, s7, 7168
  v_lshrrev_b32 v1, 5, v2
  v_mul_u32_u24 v1, 114688, v1
  v_bfe_u32 v11, v2, 2, 3
  v_lshl_add_u32 v1, v11, 7, v1
  v_add_u32 v2, s7, v1
  s_waitcnt vmcnt(8)
  s_barrier
  ds_read_b64_tr_b16 v[128:129], v13 offset:32768
  ds_read_b64_tr_b16 v[130:131], v13 offset:33024
  ds_read_b64_tr_b16 v[132:133], v14 offset:32768
  ds_read_b64_tr_b16 v[134:135], v14 offset:33024
  s_waitcnt lgkmcnt(0)
  v_mfma_f32_16x16x32_bf16 v[112:115], v[96:99], v[128:131], 0
  buffer_load_dwordx4 v12, s[8:11], s16 offen offset:2048 sc1 lds
  v_mfma_f32_16x16x32_bf16 v[116:119], v[96:99], v[132:135], 0
  buffer_load_dwordx4 v12, s[8:11], s16 offen offset:3072 sc1 lds
  s_waitcnt vmcnt(8)
  ds_read_b64_tr_b16 v[136:137], v13 offset:34816
  s_add_u32 m0, s18, 102400
  ds_read_b64_tr_b16 v[138:139], v13 offset:35072
  s_add_u32 s16, s16, 4096
  ds_read_b64_tr_b16 v[140:141], v14 offset:34816
  ds_read_b64_tr_b16 v[142:143], v14 offset:35072
  buffer_load_dwordx4 v12, s[8:11], s16 offen offset:0 sc1 lds
  ds_read_b128 v[64:67], v3 offset:0
  v_cmp_u_f32 vcc, v112, v116
  ds_read_b128 v[68:71], v3 offset:1024
  ds_read_b128 v[72:75], v3 offset:32768
  ds_read_b128 v[76:79], v3 offset:33792
  s_waitcnt lgkmcnt(4)
  buffer_load_dwordx4 v12, s[8:11], s16 offen offset:1024 sc1 lds
L_xb0:
  s_cbranch_vccnz L_xr0
L_xo0:
  v_mfma_f32_16x16x32_bf16 v[120:123], v[96:99], v[136:139], v[112:115]
  buffer_load_dwordx4 v12, s[8:11], s16 offen offset:2048 sc1 lds
  v_mfma_f32_16x16x32_bf16 v[124:127], v[96:99], v[140:143], v[116:119]
  s_waitcnt lgkmcnt(2)
  buffer_load_dwordx4 v12, s[8:11], s16 offen offset:3072 sc1 lds
  v_mfma_f32_16x16x32_bf16 v[32:35], v[64:67], v[128:131], 0
  s_waitcnt vmcnt(10)
  ds_read_b64_tr_b16 v[144:145], v13 offset:36864
  v_mfma_f32_16x16x32_bf16 v[36:39], v[64:67], v[132:135], 0
  ds_read_b64_tr_b16 v[146:147], v13 offset:37120
  v_mfma_f32_16x16x32_bf16 v[44:47], v[68:71], v[132:135], 0
  ds_read_b64_tr_b16 v[148:149], v14 offset:36864
  v_mfma_f32_16x16x32_bf16 v[40:43], v[68:71], v[128:131], 0
  s_waitcnt lgkmcnt(3)
  ds_read_b64_tr_b16 v[150:151], v14 offset:37120
  v_mfma_f32_16x16x32_bf16 v[48:51], v[72:75], v[128:131], 0
  ds_read_b128 v[80:83], v3 offset:2048
  v_mfma_f32_16x16x32_bf16 v[52:55], v[72:75], v[132:135], 0
  ds_read_b128 v[84:87], v3 offset:3072
  v_cmp_u_f32 vcc, v120, v124
  v_mfma_f32_16x16x32_bf16 v[60:63], v[76:79], v[132:135], 0
  ds_read_b128 v[88:91], v3 offset:34816
  v_mfma_f32_16x16x32_bf16 v[56:59], v[76:79], v[128:131], 0
  ds_read_b128 v[92:95], v3 offset:35840
  v_mfma_f32_16x16x32_bf16 a[224:227], v[128:131], v[128:131], 0
  v_mfma_f32_16x16x32_bf16 a[228:231], v[132:135], v[132:135], 0
  s_waitcnt lgkmcnt(4)
L_xb1:
  s_cbranch_vccnz L_xr1
L_xo1:
  v_mfma_f32_16x16x32_bf16 v[112:115], v[96:99], v[144:147], v[120:123]
  s_add_u32 m0, s18, 131072
  v_mfma_f32_16x16x32_bf16 v[116:119], v[96:99], v[148:151], v[124:127]
  s_waitcnt lgkmcnt(2)
  s_add_u32 s16, s16, 4096
  v_mfma_f32_16x16x32_bf16 v[32:35], v[80:83], v[136:139], v[32:35]
  s_waitcnt vmcnt(8)
  ds_read_b64_tr_b16 v[152:153], v13 offset:38912
  v_mfma_f32_16x16x32_bf16 v[36:39], v[80:83], v[140:143], v[36:39]
  ds_read_b64_tr_b16 v[154:155], v13 offset:39168
  v_mfma_f32_16x16x32_bf16 v[44:47], v[84:87], v[140:143], v[44:47]
  ds_read_b64_tr_b16 v[156:157], v14 offset:38912
  v_mfma_f32_16x16x32_bf16 v[40:43], v[84:87], v[136:139], v[40:43]
  s_waitcnt lgkmcnt(3)
  ds_read_b64_tr_b16 v[158:159], v14 offset:39168
  v_mfma_f32_16x16x32_bf16 v[48:51], v[88:91], v[136:139], v[48:51]
  buffer_load_dwordx4 v12, s[8:11], s16 offen offset:0 sc1 lds
  v_mfma_f32_16x16x32_bf16 v[52:55], v[88:91], v[140:143], v[52:55]
  ds_read_b128 v[64:67], v3 offset:4096
  v_cmp_u_f32 vcc, v112, v116
  v_mfma_f32_16x16x32_bf16 v[60:63], v[92:95], v[140:143], v[60:63]
  ds_read_b128 v[68:71], v3 offset:5120
  v_mfma_f32_16x16x32_bf16 v[56:59], v[92:95], v[136:139], v[56:59]
  ds_read_b128 v[72:75], v3 offset:36864
  v_mfma_f32_16x16x32_bf16 a[224:227], v[136:139], v[136:139], a[224:227]
  ds_read_b128 v[76:79], v3 offset:37888
  v_mfma_f32_16x16x32_bf16 a[228:231], v[140:143], v[140:143], a[228:231]
  s_waitcnt lgkmcnt(4)
  buffer_load_dwordx4 v12, s[8:11], s16 offen offset:1024 sc1 lds
L_xb2:
  s_cbranch_vccnz L_xr2
L_xo2:
  v_mfma_f32_16x16x32_bf16 v[120:123], v[96:99], v[152:155], v[112:115]
  buffer_load_dwordx4 v12, s[8:11], s16 offen offset:2048 sc1 lds
  v_mfma_f32_16x16x32_bf16 v[124:127], v[96:99], v[156:159], v[116:119]
  s_waitcnt lgkmcnt(2)
  buffer_load_dwordx4 v12, s[8:11], s16 offen offset:3072 sc1 lds
  v_mfma_f32_16x16x32_bf16 v[32:35], v[64:67], v[144:147], v[32:35]
  s_waitcnt vmcnt(10)
  ds_read_b64_tr_b16 v[160:161], v13 offset:0
  v_mfma_f32_16x16x32_bf16 v[36:39], v[64:67], v[148:151], v[36:39]
  ds_read_b64_tr_b16 v[162:163], v13 offset:256
  v_mfma_f32_16x16x32_bf16 v[44:47], v[68:71], v[148:151], v[44:47]
  ds_read_b64_tr_b16 v[164:165], v14 offset:0
  v_mfma_f32_16x16x32_bf16 v[40:43], v[68:71], v[144:147], v[40:43]
  s_waitcnt lgkmcnt(3)
  ds_read_b64_tr_b16 v[166:167], v14 offset:256
  v_mfma_f32_16x16x32_bf16 v[48:51], v[72:75], v[144:147], v[48:51]
  ds_read_b128 v[80:83], v3 offset:6144
  v_mfma_f32_16x16x32_bf16 v[52:55], v[72:75], v[148:151], v[52:55]
  ds_read_b128 v[84:87], v3 offset:7168
  v_cmp_u_f32 vcc, v120, v124
  v_mfma_f32_16x16x32_bf16 v[60:63], v[76:79], v[148:151], v[60:63]
  ds_read_b128 v[88:91], v3 offset:38912
  v_mfma_f32_16x16x32_bf16 v[56:59], v[76:79], v[144:147], v[56:59]
  ds_read_b128 v[92:95], v3 offset:39936
  v_mfma_f32_16x16x32_bf16 a[224:227], v[144:147], v[144:147], a[224:227]
  v_mfma_f32_16x16x32_bf16 a[228:231], v[148:151], v[148:151], a[228:231]
  s_waitcnt lgkmcnt(4)
L_xb3:
  s_cbranch_vccnz L_xr3
L_xo3:
  v_mfma_f32_16x16x32_bf16 v[112:115], v[96:99], v[160:163], v[120:123]
  s_add_u32 m0, s18, 135168
  v_mfma_f32_16x16x32_bf16 v[116:119], v[96:99], v[164:167], v[124:127]
  s_waitcnt lgkmcnt(2)
  s_add_u32 s16, s16, 4096
  v_mfma_f32_16x16x32_bf16 v[32:35], v[80:83], v[152:155], v[32:35]
  s_waitcnt vmcnt(8)
  ds_read_b64_tr_b16 v[168:169], v13 offset:2048
  v_mfma_f32_16x16x32_bf16 v[36:39], v[80:83], v[156:159], v[36:39]
  ds_read_b64_tr_b16 v[170:171], v13 offset:2304
  v_mfma_f32_16x16x32_bf16 v[44:47], v[84:87], v[156:159], v[44:47]
  ds_read_b64_tr_b16 v[172:173], v14 offset:2048
  v_mfma_f32_16x16x32_bf16 v[40:43], v[84:87], v[152:155], v[40:43]
  s_waitcnt lgkmcnt(3)
  ds_read_b64_tr_b16 v[174:175], v14 offset:2304
  v_mfma_f32_16x16x32_bf16 v[48:51], v[88:91], v[152:155], v[48:51]
  buffer_load_dwordx4 v12, s[8:11], s16 offen offset:0 sc1 lds
  v_mfma_f32_16x16x32_bf16 v[52:55], v[88:91], v[156:159], v[52:55]
  ds_read_b128 v[64:67], v3 offset:8192
  v_cmp_u_f32 vcc, v112, v116
  v_mfma_f32_16x16x32_bf16 v[60:63], v[92:95], v[156:159], v[60:63]
  ds_read_b128 v[68:71], v3 offset:9216
  v_mfma_f32_16x16x32_bf16 v[56:59], v[92:95], v[152:155], v[56:59]
  ds_read_b128 v[72:75], v3 offset:40960
  v_mfma_f32_16x16x32_bf16 a[224:227], v[152:155], v[152:155], a[224:227]
  ds_read_b128 v[76:79], v3 offset:41984
  v_mfma_f32_16x16x32_bf16 a[228:231], v[156:159], v[156:159], a[228:231]
  s_waitcnt lgkmcnt(4)
  buffer_load_dwordx4 v12, s[8:11], s16 offen offset:1024 sc1 lds
L_xb4:
  s_cbranch_vccnz L_xr4
L_xo4:
  v_mfma_f32_16x16x32_bf16 v[120:123], v[96:99], v[168:171], v[112:115]
  buffer_load_dwordx4 v12, s[8:11], s16 offen offset:2048 sc1 lds
  v_mfma_f32_16x16x32_bf16 v[124:127], v[96:99], v[172:175], v[116:119]
  s_waitcnt lgkmcnt(2)
  buffer_load_dwordx4 v12, s[8:11], s16 offen offset:3072 sc1 lds
  v_mfma_f32_16x16x32_bf16 v[32:35], v[64:67], v[160:163], v[32:35]
  s_waitcnt vmcnt(10)
  ds_read_b64_tr_b16 v[176:177], v13 offset:4096
  v_mfma_f32_16x16x32_bf16 v[36:39], v[64:67], v[164:167], v[36:39]
  ds_read_b64_tr_b16 v[178:179], v13 offset:4352
  v_mfma_f32_16x16x32_bf16 v[44:47], v[68:71], v[164:167], v[44:47]
  ds_read_b64_tr_b16 v[180:181], v14 offset:4096
  v_mfma_f32_16x16x32_bf16 v[40:43], v[68:71], v[160:163], v[40:43]
  s_waitcnt lgkmcnt(3)
  ds_read_b64_tr_b16 v[182:183], v14 offset:4352
  v_mfma_f32_16x16x32_bf16 v[48:51], v[72:75], v[160:163], v[48:51]
  ds_read_b128 v[80:83], v3 offset:10240
  v_mfma_f32_16x16x32_bf16 v[52:55], v[72:75], v[164:167], v[52:55]
  ds_read_b128 v[84:87], v3 offset:11264
  v_cmp_u_f32 vcc, v120, v124
  v_mfma_f32_16x16x32_bf16 v[60:63], v[76:79], v[164:167], v[60:63]
  ds_read_b128 v[88:91], v3 offset:43008
  v_mfma_f32_16x16x32_bf16 v[56:59], v[76:79], v[160:163], v[56:59]
  ds_read_b128 v[92:95], v3 offset:44032
  v_mfma_f32_16x16x32_bf16 a[224:227], v[160:163], v[160:163], a[224:227]
  v_mfma_f32_16x16x32_bf16 a[228:231], v[164:167], v[164:167], a[228:231]
  s_waitcnt lgkmcnt(4)
L_xb5:
  s_cbranch_vccnz L_xr5
L_xo5:
  v_mfma_f32_16x16x32_bf16 v[112:115], v[96:99], v[176:179], v[120:123]
  s_add_u32 m0, s18, 98304
  v_mfma_f32_16x16x32_bf16 v[116:119], v[96:99], v[180:183], v[124:127]
  s_waitcnt lgkmcnt(2)
  s_add_u32 s16, s16, 4096
  v_mfma_f32_16x16x32_bf16 v[32:35], v[80:83], v[168:171], v[32:35]
  s_waitcnt vmcnt(8)
  ds_read_b64_tr_b16 v[184:185], v13 offset:6144
  v_mfma_f32_16x16x32_bf16 v[36:39], v[80:83], v[172:175], v[36:39]
  ds_read_b64_tr_b16 v[186:187], v13 offset:6400
  v_mfma_f32_16x16x32_bf16 v[44:47], v[84:87], v[172:175], v[44:47]
  ds_read_b64_tr_b16 v[188:189], v14 offset:6144
  v_mfma_f32_16x16x32_bf16 v[40:43], v[84:87], v[168:171], v[40:43]
  s_waitcnt lgkmcnt(3)
  ds_read_b64_tr_b16 v[190:191], v14 offset:6400
  v_mfma_f32_16x16x32_bf16 v[48:51], v[88:91], v[168:171], v[48:51]
  buffer_load_dwordx4 v12, s[8:11], s16 offen offset:0 sc1 lds
  v_mfma_f32_16x16x32_bf16 v[52:55], v[88:91], v[172:175], v[52:55]
  ds_read_b128 v[64:67], v3 offset:12288
  v_cmp_u_f32 vcc, v112, v116
  v_mfma_f32_16x16x32_bf16 v[60:63], v[92:95], v[172:175], v[60:63]
  ds_read_b128 v[68:71], v3 offset:13312
  v_mfma_f32_16x16x32_bf16 v[56:59], v[92:95], v[168:171], v[56:59]
  ds_read_b128 v[72:75], v3 offset:45056
  v_mfma_f32_16x16x32_bf16 a[224:227], v[168:171], v[168:171], a[224:227]
  ds_read_b128 v[76:79], v3 offset:46080
  v_mfma_f32_16x16x32_bf16 a[228:231], v[172:175], v[172:175], a[228:231]
  s_waitcnt lgkmcnt(4)
  buffer_load_dwordx4 v12, s[8:11], s16 offen offset:1024 sc1 lds
L_xb6:
  s_cbranch_vccnz L_xr6
L_xo6:
  v_mfma_f32_16x16x32_bf16 v[120:123], v[96:99], v[184:187], v[112:115]
  buffer_load_dwordx4 v12, s[8:11], s16 offen offset:2048 sc1 lds
  v_mfma_f32_16x16x32_bf16 v[124:127], v[96:99], v[188:191], v[116:119]
  s_waitcnt lgkmcnt(2)
  buffer_load_dwordx4 v12, s[8:11], s16 offen offset:3072 sc1 lds
  v_mfma_f32_16x16x32_bf16 v[32:35], v[64:67], v[176:179], v[32:35]
  s_waitcnt vmcnt(10)
  ds_read_b64_tr_b16 v[192:193], v13 offset:32768
  v_mfma_f32_16x16x32_bf16 v[36:39], v[64:67], v[180:183], v[36:39]
  ds_read_b64_tr_b16 v[194:195], v13 offset:33024
  v_mfma_f32_16x16x32_bf16 v[44:47], v[68:71], v[180:183], v[44:47]
  ds_read_b64_tr_b16 v[196:197], v14 offset:32768
  v_mfma_f32_16x16x32_bf16 v[40:43], v[68:71], v[176:179], v[40:43]
  s_waitcnt lgkmcnt(3)
  ds_read_b64_tr_b16 v[198:199], v14 offset:33024
  v_mfma_f32_16x16x32_bf16 v[48:51], v[72:75], v[176:179], v[48:51]
  ds_read_b128 v[80:83], v3 offset:14336
  v_mfma_f32_16x16x32_bf16 v[52:55], v[72:75], v[180:183], v[52:55]
  ds_read_b128 v[84:87], v3 offset:15360
  v_cmp_u_f32 vcc, v120, v124
  v_mfma_f32_16x16x32_bf16 v[60:63], v[76:79], v[180:183], v[60:63]
  ds_read_b128 v[88:91], v3 offset:47104
  v_mfma_f32_16x16x32_bf16 v[56:59], v[76:79], v[176:179], v[56:59]
  ds_read_b128 v[92:95], v3 offset:48128
  v_mfma_f32_16x16x32_bf16 a[224:227], v[176:179], v[176:179], a[224:227]
  v_mfma_f32_16x16x32_bf16 a[228:231], v[180:183], v[180:183], a[228:231]
  s_waitcnt lgkmcnt(4)
L_xb7:
  s_cbranch_vccnz L_xr7
L_xo7:
  v_mfma_f32_16x16x32_bf16 v[112:115], v[96:99], v[192:195], v[120:123]
  s_add_u32 m0, s18, 102400
  v_mfma_f32_16x16x32_bf16 v[116:119], v[96:99], v[196:199], v[124:127]
  s_waitcnt lgkmcnt(2)
  s_add_u32 s16, s16, 4096
  v_mfma_f32_16x16x32_bf16 v[32:35], v[80:83], v[184:187], v[32:35]
  s_waitcnt vmcnt(8)
  ds_read_b64_tr_b16 v[200:201], v13 offset:34816
  v_mfma_f32_16x16x32_bf16 v[36:39], v[80:83], v[188:191], v[36:39]
  ds_read_b64_tr_b16 v[202:203], v13 offset:35072
  v_mfma_f32_16x16x32_bf16 v[44:47], v[84:87], v[188:191], v[44:47]
  ds_read_b64_tr_b16 v[204:205], v14 offset:34816
  v_mfma_f32_16x16x32_bf16 v[40:43], v[84:87], v[184:187], v[40:43]
  s_waitcnt lgkmcnt(3)
  ds_read_b64_tr_b16 v[206:207], v14 offset:35072
  v_mfma_f32_16x16x32_bf16 v[48:51], v[88:91], v[184:187], v[48:51]
  buffer_load_dwordx4 v12, s[8:11], s16 offen offset:0 sc1 lds
  v_mfma_f32_16x16x32_bf16 v[52:55], v[88:91], v[188:191], v[52:55]
  ds_read_b128 v[64:67], v3 offset:16384
  v_cmp_u_f32 vcc, v112, v116
  v_mfma_f32_16x16x32_bf16 v[60:63], v[92:95], v[188:191], v[60:63]
  ds_read_b128 v[68:71], v3 offset:17408
  v_mfma_f32_16x16x32_bf16 v[56:59], v[92:95], v[184:187], v[56:59]
  ds_read_b128 v[72:75], v3 offset:49152
  v_mfma_f32_16x16x32_bf16 a[224:227], v[184:187], v[184:187], a[224:227]
  ds_read_b128 v[76:79], v3 offset:50176
  v_mfma_f32_16x16x32_bf16 a[228:231], v[188:191], v[188:191], a[228:231]
  s_waitcnt lgkmcnt(4)
  buffer_load_dwordx4 v12, s[8:11], s16 offen offset:1024 sc1 lds
L_xb8:
  s_cbranch_vccnz L_xr8
L_xo8:
  v_mfma_f32_16x16x32_bf16 v[120:123], v[96:99], v[200:203], v[112:115]
  buffer_load_dwordx4 v12, s[8:11], s16 offen offset:2048 sc1 lds
  v_mfma_f32_16x16x32_bf16 v[124:127], v[96:99], v[204:207], v[116:119]
  s_waitcnt lgkmcnt(2)
  buffer_load_dwordx4 v12, s[8:11], s16 offen offset:3072 sc1 lds
  v_mfma_f32_16x16x32_bf16 v[32:35], v[64:67], v[192:195], v[32:35]
  s_waitcnt vmcnt(10)
  ds_read_b64_tr_b16 v[208:209], v13 offset:36864
  s_add_u32 m0, s18, 131072
  v_mfma_f32_16x16x32_bf16 v[36:39], v[64:67], v[196:199], v[36:39]
  ds_read_b64_tr_b16 v[210:211], v13 offset:37120
  v_mfma_f32_16x16x32_bf16 v[44:47], v[68:71], v[196:199], v[44:47]
  ds_read_b64_tr_b16 v[212:213], v14 offset:36864
  v_mfma_f32_16x16x32_bf16 v[40:43], v[68:71], v[192:195], v[40:43]
  s_waitcnt lgkmcnt(3)
  ds_read_b64_tr_b16 v[214:215], v14 offset:37120
  v_mfma_f32_16x16x32_bf16 v[48:51], v[72:75], v[192:195], v[48:51]
  buffer_load_dwordx4 v3, s[8:11], s19 offen offset:0 sc1 lds
  v_mfma_f32_16x16x32_bf16 v[52:55], v[72:75], v[196:199], v[52:55]
  ds_read_b128 v[80:83], v3 offset:18432
  v_cmp_u_f32 vcc, v120, v124
  v_mfma_f32_16x16x32_bf16 v[60:63], v[76:79], v[196:199], v[60:63]
  ds_read_b128 v[84:87], v3 offset:19456
  v_mfma_f32_16x16x32_bf16 v[56:59], v[76:79], v[192:195], v[56:59]
  ds_read_b128 v[88:91], v3 offset:51200
  v_mfma_f32_16x16x32_bf16 a[224:227], v[192:195], v[192:195], a[224:227]
  ds_read_b128 v[92:95], v3 offset:52224
  v_mfma_f32_16x16x32_bf16 a[228:231], v[196:199], v[196:199], a[228:231]
  s_waitcnt lgkmcnt(4)
  buffer_load_dwordx4 v3, s[8:11], s19 offen offset:1024 sc1 lds
L_xb9:
  s_cbranch_vccnz L_xr9
L_xo9:
  v_mfma_f32_16x16x32_bf16 v[112:115], v[96:99], v[208:211], v[120:123]
  s_add_u32 m0, s18, 65536
  v_mfma_f32_16x16x32_bf16 v[116:119], v[96:99], v[212:215], v[124:127]
  s_waitcnt lgkmcnt(2)
  s_add_u32 s17, s17, 28672
  v_mfma_f32_16x16x32_bf16 v[32:35], v[80:83], v[200:203], v[32:35]
  s_waitcnt vmcnt(10)
  ds_read_b64_tr_b16 v[216:217], v13 offset:38912
  v_mfma_f32_16x16x32_bf16 v[36:39], v[80:83], v[204:207], v[36:39]
  ds_read_b64_tr_b16 v[218:219], v13 offset:39168
  v_mfma_f32_16x16x32_bf16 v[44:47], v[84:87], v[204:207], v[44:47]
  ds_read_b64_tr_b16 v[220:221], v14 offset:38912
  v_mfma_f32_16x16x32_bf16 v[40:43], v[84:87], v[200:203], v[40:43]
  s_waitcnt lgkmcnt(3)
  ds_read_b64_tr_b16 v[222:223], v14 offset:39168
  v_mfma_f32_16x16x32_bf16 v[48:51], v[88:91], v[200:203], v[48:51]
  buffer_load_dwordx4 v3, s[8:11], s17 offen offset:0 sc1 lds
  v_mfma_f32_16x16x32_bf16 v[52:55], v[88:91], v[204:207], v[52:55]
  ds_read_b128 v[64:67], v3 offset:20480
  v_cmp_u_f32 vcc, v112, v116
  v_mfma_f32_16x16x32_bf16 v[60:63], v[92:95], v[204:207], v[60:63]
  ds_read_b128 v[68:71], v3 offset:21504
  v_mfma_f32_16x16x32_bf16 v[56:59], v[92:95], v[200:203], v[56:59]
  ds_read_b128 v[72:75], v3 offset:53248
  v_mfma_f32_16x16x32_bf16 a[224:227], v[200:203], v[200:203], a[224:227]
  ds_read_b128 v[76:79], v3 offset:54272
  v_mfma_f32_16x16x32_bf16 a[228:231], v[204:207], v[204:207], a[228:231]
  s_waitcnt lgkmcnt(4)
  buffer_load_dwordx4 v3, s[8:11], s17 offen offset:1024 sc1 lds
L_xb10:
  s_cbranch_vccnz L_xr10
L_xo10:
  v_mfma_f32_16x16x32_bf16 v[120:123], v[96:99], v[216:219], v[112:115]
  buffer_load_dwordx4 v3, s[8:11], s17 offen offset:2048 sc1 lds
  v_mfma_f32_16x16x32_bf16 v[124:127], v[96:99], v[220:223], v[116:119]
  s_waitcnt lgkmcnt(2)
  buffer_load_dwordx4 v3, s[8:11], s17 offen offset:3072 sc1 lds
  v_mfma_f32_16x16x32_bf16 v[32:35], v[64:67], v[208:211], v[32:35]
  s_waitcnt vmcnt(12)
  ds_read_b64_tr_b16 v[224:225], v13 offset:0
  s_add_u32 m0, s18, 69632
  v_mfma_f32_16x16x32_bf16 v[36:39], v[64:67], v[212:215], v[36:39]
  ds_read_b64_tr_b16 v[226:227], v13 offset:256
  s_add_u32 s17, s17, 4096
  v_mfma_f32_16x16x32_bf16 v[44:47], v[68:71], v[212:215], v[44:47]
  ds_read_b64_tr_b16 v[228:229], v14 offset:0
  v_mfma_f32_16x16x32_bf16 v[40:43], v[68:71], v[208:211], v[40:43]
  s_waitcnt lgkmcnt(3)
  ds_read_b64_tr_b16 v[230:231], v14 offset:256
  v_mfma_f32_16x16x32_bf16 v[48:51], v[72:75], v[208:211], v[48:51]
  buffer_load_dwordx4 v3, s[8:11], s17 offen offset:0 sc1 lds
  v_mfma_f32_16x16x32_bf16 v[52:55], v[72:75], v[212:215], v[52:55]
  ds_read_b128 v[80:83], v3 offset:22528
  v_cmp_u_f32 vcc, v120, v124
  v_mfma_f32_16x16x32_bf16 v[60:63], v[76:79], v[212:215], v[60:63]
  ds_read_b128 v[84:87], v3 offset:23552
  v_mfma_f32_16x16x32_bf16 v[56:59], v[76:79], v[208:211], v[56:59]
  ds_read_b128 v[88:91], v3 offset:55296
  v_mfma_f32_16x16x32_bf16 a[224:227], v[208:211], v[208:211], a[224:227]
  ds_read_b128 v[92:95], v3 offset:56320
  v_mfma_f32_16x16x32_bf16 a[228:231], v[212:215], v[212:215], a[228:231]
  s_waitcnt lgkmcnt(4)
  buffer_load_dwordx4 v3, s[8:11], s17 offen offset:1024 sc1 lds
L_xb11:
  s_cbranch_vccnz L_xr11
L_xo11:
  v_mfma_f32_16x16x32_bf16 v[112:115], v[96:99], v[224:227], v[120:123]
  buffer_load_dwordx4 v3, s[8:11], s17 offen offset:2048 sc1 lds
  v_mfma_f32_16x16x32_bf16 v[116:119], v[96:99], v[228:231], v[124:127]
  s_waitcnt lgkmcnt(2)
  buffer_load_dwordx4 v3, s[8:11], s17 offen offset:3072 sc1 lds
  v_mfma_f32_16x16x32_bf16 v[32:35], v[80:83], v[216:219], v[32:35]
  s_waitcnt vmcnt(14)
  ds_read_b64_tr_b16 v[232:233], v13 offset:2048
  v_mfma_f32_16x16x32_bf16 v[36:39], v[80:83], v[220:223], v[36:39]
  ds_read_b64_tr_b16 v[234:235], v13 offset:2304
  v_mfma_f32_16x16x32_bf16 v[44:47], v[84:87], v[220:223], v[44:47]
  ds_read_b64_tr_b16 v[236:237], v14 offset:2048
  v_mfma_f32_16x16x32_bf16 v[40:43], v[84:87], v[216:219], v[40:43]
  s_waitcnt lgkmcnt(3)
  ds_read_b64_tr_b16 v[238:239], v14 offset:2304
  v_mfma_f32_16x16x32_bf16 v[48:51], v[88:91], v[216:219], v[48:51]
  ds_read_b128 v[64:67], v3 offset:24576
  v_mfma_f32_16x16x32_bf16 v[52:55], v[88:91], v[220:223], v[52:55]
  ds_read_b128 v[68:71], v3 offset:25600
  v_cmp_u_f32 vcc, v112, v116
  v_mfma_f32_16x16x32_bf16 v[60:63], v[92:95], v[220:223], v[60:63]
  ds_read_b128 v[72:75], v3 offset:57344
  v_mfma_f32_16x16x32_bf16 v[56:59], v[92:95], v[216:219], v[56:59]
  ds_read_b128 v[76:79], v3 offset:58368
  v_mfma_f32_16x16x32_bf16 a[224:227], v[216:219], v[216:219], a[224:227]
  v_mfma_f32_16x16x32_bf16 a[228:231], v[220:223], v[220:223], a[228:231]
  s_waitcnt lgkmcnt(4)
L_xb12:
  s_cbranch_vccnz L_xr12
L_xo12:
  v_mfma_f32_16x16x32_bf16 v[120:123], v[96:99], v[232:235], v[112:115]
  v_mfma_f32_16x16x32_bf16 v[124:127], v[96:99], v[236:239], v[116:119]
  s_waitcnt lgkmcnt(2)
  v_mfma_f32_16x16x32_bf16 v[32:35], v[64:67], v[224:227], v[32:35]
  s_waitcnt vmcnt(12)
  ds_read_b64_tr_b16 v[240:241], v13 offset:4096
  v_mfma_f32_16x16x32_bf16 v[36:39], v[64:67], v[228:231], v[36:39]
  ds_read_b64_tr_b16 v[242:243], v13 offset:4352
  v_mfma_f32_16x16x32_bf16 v[44:47], v[68:71], v[228:231], v[44:47]
  ds_read_b64_tr_b16 v[244:245], v14 offset:4096
  v_mfma_f32_16x16x32_bf16 v[40:43], v[68:71], v[224:227], v[40:43]
  s_waitcnt lgkmcnt(3)
  ds_read_b64_tr_b16 v[246:247], v14 offset:4352
  v_mfma_f32_16x16x32_bf16 v[48:51], v[72:75], v[224:227], v[48:51]
  ds_read_b128 v[80:83], v3 offset:26624
  v_mfma_f32_16x16x32_bf16 v[52:55], v[72:75], v[228:231], v[52:55]
  ds_read_b128 v[84:87], v3 offset:27648
  v_cmp_u_f32 vcc, v120, v124
  v_mfma_f32_16x16x32_bf16 v[60:63], v[76:79], v[228:231], v[60:63]
  ds_read_b128 v[88:91], v3 offset:59392
  v_mfma_f32_16x16x32_bf16 v[56:59], v[76:79], v[224:227], v[56:59]
  ds_read_b128 v[92:95], v3 offset:60416
  v_mfma_f32_16x16x32_bf16 a[224:227], v[224:227], v[224:227], a[224:227]
  v_mfma_f32_16x16x32_bf16 a[228:231], v[228:231], v[228:231], a[228:231]
  s_waitcnt lgkmcnt(4)
L_xb13:
  s_cbranch_vccnz L_xr13
L_xo13:
  v_mfma_f32_16x16x32_bf16 v[112:115], v[96:99], v[240:243], v[120:123]
  s_add_u32 m0, s18, 98304
  v_mfma_f32_16x16x32_bf16 v[116:119], v[96:99], v[244:247], v[124:127]
  s_waitcnt lgkmcnt(2)
  v_mfma_f32_16x16x32_bf16 v[32:35], v[80:83], v[232:235], v[32:35]
  s_waitcnt vmcnt(10)
  ds_read_b64_tr_b16 v[248:249], v13 offset:6144
  v_mfma_f32_16x16x32_bf16 v[36:39], v[80:83], v[236:239], v[36:39]
  ds_read_b64_tr_b16 v[250:251], v13 offset:6400
  s_add_u32 s17, s17, 28672
  v_mfma_f32_16x16x32_bf16 v[44:47], v[84:87], v[236:239], v[44:47]
  ds_read_b64_tr_b16 v[252:253], v14 offset:6144
  v_mfma_f32_16x16x32_bf16 v[40:43], v[84:87], v[232:235], v[40:43]
  s_waitcnt lgkmcnt(3)
  ds_read_b64_tr_b16 v[254:255], v14 offset:6400
  v_mfma_f32_16x16x32_bf16 v[48:51], v[88:91], v[232:235], v[48:51]
  buffer_load_dwordx4 v3, s[8:11], s17 offen offset:0 sc1 lds
  v_mfma_f32_16x16x32_bf16 v[52:55], v[88:91], v[236:239], v[52:55]
  ds_read_b128 v[64:67], v3 offset:28672
  v_cmp_u_f32 vcc, v112, v116
  v_mfma_f32_16x16x32_bf16 v[60:63], v[92:95], v[236:239], v[60:63]
  ds_read_b128 v[68:71], v3 offset:29696
  v_mfma_f32_16x16x32_bf16 v[56:59], v[92:95], v[232:235], v[56:59]
  ds_read_b128 v[72:75], v3 offset:61440
  v_mfma_f32_16x16x32_bf16 a[224:227], v[232:235], v[232:235], a[224:227]
  ds_read_b128 v[76:79], v3 offset:62464
  v_mfma_f32_16x16x32_bf16 a[228:231], v[236:239], v[236:239], a[228:231]
  s_waitcnt lgkmcnt(4)
L_xb14:
  s_cbranch_vccnz L_xr14
L_xo14:
  v_mfma_f32_16x16x32_bf16 v[120:123], v[96:99], v[248:251], v[112:115]
  buffer_load_dwordx4 v3, s[8:11], s17 offen offset:1024 sc1 lds
  v_mfma_f32_16x16x32_bf16 v[124:127], v[96:99], v[252:255], v[116:119]
  s_waitcnt lgkmcnt(2)
  v_mfma_f32_16x16x32_bf16 v[32:35], v[64:67], v[240:243], v[32:35]
  ds_read_b128 v[80:83], v3 offset:30720
  v_mfma_f32_16x16x32_bf16 v[36:39], v[64:67], v[244:247], v[36:39]
  ds_read_b128 v[84:87], v3 offset:31744
  v_mfma_f32_16x16x32_bf16 v[44:47], v[68:71], v[244:247], v[44:47]
  ds_read_b128 v[88:91], v3 offset:63488
  v_mfma_f32_16x16x32_bf16 v[40:43], v[68:71], v[240:243], v[40:43]
  s_waitcnt lgkmcnt(3)
  ds_read_b128 v[92:95], v3 offset:64512
  v_mfma_f32_16x16x32_bf16 v[48:51], v[72:75], v[240:243], v[48:51]
  buffer_load_dwordx4 v3, s[8:11], s17 offen offset:2048 sc1 lds
  v_mfma_f32_16x16x32_bf16 v[52:55], v[72:75], v[244:247], v[52:55]
  v_cmp_u_f32 vcc, v120, v124
  v_mfma_f32_16x16x32_bf16 v[60:63], v[76:79], v[244:247], v[60:63]
  v_mfma_f32_16x16x32_bf16 v[56:59], v[76:79], v[240:243], v[56:59]
  buffer_load_dwordx4 v3, s[8:11], s17 offen offset:3072 sc1 lds
  v_mfma_f32_16x16x32_bf16 a[224:227], v[240:243], v[240:243], a[224:227]
  v_mfma_f32_16x16x32_bf16 a[228:231], v[244:247], v[244:247], a[228:231]
  s_waitcnt lgkmcnt(0)
L_xb15:
  s_cbranch_vccnz L_xr15
L_xo15:
  v_mfma_f32_16x16x32_bf16 v[32:35], v[80:83], v[248:251], v[32:35]
  s_add_u32 m0, s18, 102400
  s_add_u32 s17, s17, 4096
  buffer_load_dwordx4 v3, s[8:11], s17 offen offset:0 sc1 lds
  v_mfma_f32_16x16x32_bf16 v[36:39], v[80:83], v[252:255], v[36:39]
  v_mfma_f32_16x16x32_bf16 v[44:47], v[84:87], v[252:255], v[44:47]
  v_mfma_f32_16x16x32_bf16 v[40:43], v[84:87], v[248:251], v[40:43]
  buffer_load_dwordx4 v3, s[8:11], s17 offen offset:1024 sc1 lds
  v_mfma_f32_16x16x32_bf16 v[48:51], v[88:91], v[248:251], v[48:51]
  v_mfma_f32_16x16x32_bf16 v[52:55], v[88:91], v[252:255], v[52:55]
  v_mfma_f32_16x16x32_bf16 v[60:63], v[92:95], v[252:255], v[60:63]
  buffer_load_dwordx4 v3, s[8:11], s17 offen offset:2048 sc1 lds
  v_mfma_f32_16x16x32_bf16 v[56:59], v[92:95], v[248:251], v[56:59]
  v_mfma_f32_16x16x32_bf16 a[224:227], v[248:251], v[248:251], a[224:227]
  v_mfma_f32_16x16x32_bf16 a[228:231], v[252:255], v[252:255], a[228:231]
  buffer_load_dwordx4 v3, s[8:11], s17 offen offset:3072 sc1 lds
  v_permlane32_swap_b32 v120, v124
  s_nop 4
  v_accvgpr_read_b32 v112, a224
  v_accvgpr_read_b32 v113, a225
  v_accvgpr_read_b32 v114, a226
  v_accvgpr_read_b32 v115, a227
  v_accvgpr_read_b32 v116, a228
  v_accvgpr_read_b32 v117, a229
  v_accvgpr_read_b32 v118, a230
  v_accvgpr_read_b32 v119, a231
  s_waitcnt vmcnt(8)
  s_barrier
  ds_read_b64 v[64:65], v16 offset:0
  ds_read_b64 v[68:69], v16 offset:128
  ds_read_b64 v[72:73], v16 offset:256
  ds_read_b64 v[76:77], v16 offset:384
  ds_read_b128 v[80:83], v15 offset:0
  ds_read_b128 v[84:87], v15 offset:1024
  v_cndmask_b32 v112, v112, v113, s[52:53]
  v_cndmask_b32 v114, v114, v115, s[52:53]
  v_cndmask_b32 v116, v116, v117, s[52:53]
  v_cndmask_b32 v118, v118, v119, s[52:53]
  v_cndmask_b32 v112, v112, v114, s[56:57]
  v_cndmask_b32 v116, v116, v118, s[56:57]
  v_cndmask_b32 v112, 0, v112, s[54:55]
  v_cndmask_b32 v116, 0, v116, s[54:55]
  v_mul_f32 v120, s34, v120
  v_cvt_pk_bf16_f32 v104, -v120, -v120
  v_permlane32_swap_b32 v112, v116
  v_add_f32 v112, v112, v116
  v_mov_b32 v113, v112
  v_mov_b32 v108, v104
  v_mul_f32 v120, v120, v120
  v_permlane16_swap_b32 v112, v113
  v_permlane32_swap_b32 v104, v108
  v_add_f32 v112, v112, v113
  v_fma_f32 v112, v112, s34, -v120
  v_max_f32 v112, 0, v112
  v_cvt_pk_bf16_f32 v112, v112, v112
  v_lshlrev_b32 v112, 16, v112
  v_add_f32 v112, s35, v112
  v_cvt_pk_bf16_f32 v112, v112, v112
  v_lshlrev_b32 v112, 16, v112
  v_sqrt_f32 v112, v112
  s_nop 0
  v_cvt_pk_bf16_f32 v105, v112, v112
  v_cvt_pk_bf16_f32 v109, v112, v112
  v_lshlrev_b32 v101, 16, v105
  v_rcp_f32 v100, v101
  v_permlane32_swap_b32 v105, v109
  s_waitcnt lgkmcnt(4)
  s_nop 0
  v_mfma_f32_16x16x32_bf16 v[32:35], v[64:67], v[104:107], v[32:35]
  ds_read_b128 v[88:91], v15 offset:2048
  v_mul_f32_e64 v100, -v100, s32
  v_mfma_f32_16x16x32_bf16 v[36:39], v[64:67], v[108:111], v[36:39]
  v_mov_b32 v103, v101
  v_mov_b32 v102, v100
  v_mfma_f32_16x16x32_bf16 v[44:47], v[68:71], v[108:111], v[44:47]
  ds_read_b128 v[92:95], v15 offset:3072
  v_permlane32_swap_b32 v101, v103
  v_mfma_f32_16x16x32_bf16 v[40:43], v[68:71], v[104:107], v[40:43]
  s_waitcnt lgkmcnt(4)
  buffer_store_dwordx4 a[232:235], v3, s[8:11], s44 offen offset:2048 sc1
  v_mfma_f32_16x16x32_bf16 v[48:51], v[72:75], v[104:107], v[48:51]
  ds_read_b128 v[64:67], v15 offset:4096
  v_permlane32_swap_b32 v100, v102
  v_mfma_f32_16x16x32_bf16 v[52:55], v[72:75], v[108:111], v[52:55]
  v_mfma_f32_16x16x32_bf16 v[60:63], v[76:79], v[108:111], v[60:63]
  ds_read_b128 v[68:71], v15 offset:5120
  v_mfma_f32_16x16x32_bf16 v[56:59], v[76:79], v[104:107], v[56:59]
  s_waitcnt lgkmcnt(4)
  v_mfma_f32_16x16x32_bf16 v[112:115], v[80:83], v[128:131], 0
  s_add_u32 m0, s18, 0
  ds_read_b128 v[72:75], v15 offset:6144
  v_mul_f32 v32, v100, v32
  v_mfma_f32_16x16x32_bf16 v[116:119], v[80:83], v[132:135], 0
  s_add_u32 s17, s17, 28672
  v_exp_f32 v32, v32
  v_mfma_f32_16x16x32_bf16 v[124:127], v[84:87], v[132:135], 0
  ds_read_b128 v[76:79], v15 offset:7168
  v_mul_f32 v33, v100, v33
  v_mfma_f32_16x16x32_bf16 v[120:123], v[84:87], v[128:131], 0
  s_waitcnt lgkmcnt(4)
  buffer_store_dwordx4 a[232:235], v3, s[8:11], s44 offen offset:3072 sc1
  v_mfma_f32_16x16x32_bf16 v[112:115], v[88:91], v[136:139], v[112:115]
  ds_read_b128 v[80:83], v15 offset:8192
  v_fma_f32 v32, v32, v101, v101
  v_mfma_f32_16x16x32_bf16 v[116:119], v[88:91], v[140:143], v[116:119]
  v_exp_f32 v33, v33
  v_mfma_f32_16x16x32_bf16 v[124:127], v[92:95], v[140:143], v[124:127]
  ds_read_b128 v[84:87], v15 offset:9216
  v_mul_f32 v34, v100, v34
  v_mfma_f32_16x16x32_bf16 v[120:123], v[92:95], v[136:139], v[120:123]
  s_waitcnt lgkmcnt(4)
  buffer_load_dwordx4 v3, s[8:11], s17 offen offset:0 sc1 lds
  v_rcp_f32 v32, v32
  v_mfma_f32_16x16x32_bf16 v[112:115], v[64:67], v[144:147], v[112:115]
  ds_read_b128 v[88:91], v15 offset:10240
  v_fma_f32 v33, v33, v101, v101
  v_mfma_f32_16x16x32_bf16 v[116:119], v[64:67], v[148:151], v[116:119]
  v_exp_f32 v34, v34
  v_mfma_f32_16x16x32_bf16 v[124:127], v[68:71], v[148:151], v[124:127]
  ds_read_b128 v[92:95], v15 offset:11264
  v_mul_f32 v35, v100, v35
  v_mfma_f32_16x16x32_bf16 v[120:123], v[68:71], v[144:147], v[120:123]
  s_waitcnt lgkmcnt(4)
  buffer_store_dwordx4 a[232:235], v3, s[8:11], s45 offen offset:0 sc1
  v_rcp_f32 v33, v33
  v_mfma_f32_16x16x32_bf16 v[112:115], v[72:75], v[152:155], v[112:115]
  ds_read_b128 v[64:67], v15 offset:12288
  v_mul_f32 v32, v32, v40
  v_mfma_f32_16x16x32_bf16 v[116:119], v[72:75], v[156:159], v[116:119]
  v_exp_f32 v35, v35
  v_mfma_f32_16x16x32_bf16 v[124:127], v[76:79], v[156:159], v[124:127]
  ds_read_b128 v[68:71], v15 offset:13312
  v_fma_f32 v34, v34, v101, v101
  v_mfma_f32_16x16x32_bf16 v[120:123], v[76:79], v[152:155], v[120:123]
  s_waitcnt lgkmcnt(4)
  buffer_load_dwordx4 v3, s[8:11], s17 offen offset:1024 sc1 lds
  v_rcp_f32 v34, v34
  v_mfma_f32_16x16x32_bf16 v[112:115], v[80:83], v[160:163], v[112:115]
  ds_read_b128 v[72:75], v15 offset:14336
  v_mul_f32 v36, v102, v36
  v_mfma_f32_16x16x32_bf16 v[116:119], v[80:83], v[164:167], v[116:119]
  v_exp_f32 v36, v36
  v_mfma_f32_16x16x32_bf16 v[124:127], v[84:87], v[164:167], v[124:127]
  ds_read_b128 v[76:79], v15 offset:15360
  v_mul_f32 v33, v33, v41
  v_mfma_f32_16x16x32_bf16 v[120:123], v[84:87], v[160:163], v[120:123]
  s_waitcnt lgkmcnt(4)
  buffer_store_dwordx4 a[232:235], v3, s[8:11], s45 offen offset:1024 sc1
  v_mfma_f32_16x16x32_bf16 v[112:115], v[88:91], v[168:171], v[112:115]
  ds_read_b128 v[80:83], v15 offset:16384
  v_cvt_pk_bf16_f32 v96, v32, v33
  v_mfma_f32_16x16x32_bf16 v[116:119], v[88:91], v[172:175], v[116:119]
  v_fma_f32 v35, v35, v101, v101
  v_mul_f32 v37, v102, v37
  v_mfma_f32_16x16x32_bf16 v[124:127], v[92:95], v[172:175], v[124:127]
  ds_read_b128 v[84:87], v15 offset:17408
  v_mul_f32 v34, v34, v42
  v_mfma_f32_16x16x32_bf16 v[120:123], v[92:95], v[168:171], v[120:123]
  s_waitcnt lgkmcnt(4)
  buffer_load_dwordx4 v3, s[8:11], s17 offen offset:2048 sc1 lds
  v_rcp_f32 v35, v35
  v_mfma_f32_16x16x32_bf16 v[112:115], v[64:67], v[176:179], v[112:115]
  ds_read_b128 v[88:91], v15 offset:18432
  v_fma_f32 v36, v36, v103, v103
  v_mfma_f32_16x16x32_bf16 v[116:119], v[64:67], v[180:183], v[116:119]
  v_exp_f32 v37, v37
  v_mfma_f32_16x16x32_bf16 v[124:127], v[68:71], v[180:183], v[124:127]
  ds_read_b128 v[92:95], v15 offset:19456
  v_mul_f32 v38, v102, v38
  v_mfma_f32_16x16x32_bf16 v[120:123], v[68:71], v[176:179], v[120:123]
  s_waitcnt lgkmcnt(4)
  buffer_store_dwordx4 a[232:235], v3, s[8:11], s45 offen offset:2048 sc1
  v_rcp_f32 v36, v36
  v_mfma_f32_16x16x32_bf16 v[112:115], v[72:75], v[184:187], v[112:115]
  ds_read_b128 v[64:67], v15 offset:20480
  v_mul_f32 v35, v35, v43
  v_mfma_f32_16x16x32_bf16 v[116:119], v[72:75], v[188:191], v[116:119]
  v_exp_f32 v38, v38
  v_mfma_f32_16x16x32_bf16 v[124:127], v[76:79], v[188:191], v[124:127]
  ds_read_b128 v[68:71], v15 offset:21504
  v_cvt_pk_bf16_f32 v97, v34, v35
  v_mfma_f32_16x16x32_bf16 v[120:123], v[76:79], v[184:187], v[120:123]
  s_waitcnt lgkmcnt(4)
  buffer_load_dwordx4 v3, s[8:11], s17 offen offset:3072 sc1 lds
  v_mfma_f32_16x16x32_bf16 v[112:115], v[80:83], v[192:195], v[112:115]
  s_add_u32 m0, s18, 4096
  ds_read_b128 v[72:75], v15 offset:22528
  v_fma_f32 v37, v37, v103, v103
  v_mfma_f32_16x16x32_bf16 v[116:119], v[80:83], v[196:199], v[116:119]
  s_add_u32 s17, s17, 4096
  v_rcp_f32 v37, v37
  v_mfma_f32_16x16x32_bf16 v[124:127], v[84:87], v[196:199], v[124:127]
  ds_read_b128 v[76:79], v15 offset:23552
  v_mul_f32 v39, v102, v39
  v_mfma_f32_16x16x32_bf16 v[120:123], v[84:87], v[192:195], v[120:123]
  s_waitcnt lgkmcnt(4)
  buffer_load_dwordx4 v3, s[8:11], s17 offen offset:0 sc1 lds
  v_exp_f32 v39, v39
  v_mfma_f32_16x16x32_bf16 v[112:115], v[88:91], v[200:203], v[112:115]
  ds_read_b128 v[80:83], v15 offset:24576
  v_mul_f32 v36, v36, v44
  v_mfma_f32_16x16x32_bf16 v[116:119], v[88:91], v[204:207], v[116:119]
  v_fma_f32 v38, v38, v103, v103
  v_mul_f32 v37, v37, v45
  v_mfma_f32_16x16x32_bf16 v[124:127], v[92:95], v[204:207], v[124:127]
  ds_read_b128 v[84:87], v15 offset:25600
  v_cvt_pk_bf16_f32 v98, v36, v37
  v_mfma_f32_16x16x32_bf16 v[120:123], v[92:95], v[200:203], v[120:123]
  s_waitcnt lgkmcnt(4)
  buffer_load_dwordx4 v3, s[8:11], s17 offen offset:1024 sc1 lds
  v_mfma_f32_16x16x32_bf16 v[112:115], v[64:67], v[208:211], v[112:115]
  ds_read_b128 v[88:91], v15 offset:26624
  v_fma_f32 v39, v39, v103, v103
  v_mfma_f32_16x16x32_bf16 v[116:119], v[64:67], v[212:215], v[116:119]
  v_rcp_f32 v38, v38
  v_mfma_f32_16x16x32_bf16 v[124:127], v[68:71], v[212:215], v[124:127]
  ds_read_b128 v[92:95], v15 offset:27648
  v_mul_f32 v38, v38, v46
  v_mfma_f32_16x16x32_bf16 v[120:123], v[68:71], v[208:211], v[120:123]
  s_waitcnt lgkmcnt(4)
  buffer_load_dwordx4 v3, s[8:11], s17 offen offset:2048 sc1 lds
  v_mfma_f32_16x16x32_bf16 v[112:115], v[72:75], v[216:219], v[112:115]
  ds_read_b128 v[64:67], v15 offset:28672
  v_permlane16_swap_b32 v96, v98
  v_mfma_f32_16x16x32_bf16 v[116:119], v[72:75], v[220:223], v[116:119]
  v_rcp_f32 v39, v39
  v_mfma_f32_16x16x32_bf16 v[124:127], v[76:79], v[220:223], v[124:127]
  ds_read_b128 v[68:71], v15 offset:29696
  v_mul_f32 v39, v39, v47
  v_mfma_f32_16x16x32_bf16 v[120:123], v[76:79], v[216:219], v[120:123]
  s_waitcnt lgkmcnt(4)
  buffer_load_dwordx4 v3, s[8:11], s17 offen offset:3072 sc1 lds
  v_mfma_f32_16x16x32_bf16 v[112:115], v[80:83], v[224:227], v[112:115]
  ds_read_b128 v[72:75], v15 offset:30720
  v_cvt_pk_bf16_f32 v99, v38, v39
  v_mfma_f32_16x16x32_bf16 v[116:119], v[80:83], v[228:231], v[116:119]
  s_nop 0
  v_permlane16_swap_b32 v97, v99
  v_mul_f32 v48, v100, v48
  v_mfma_f32_16x16x32_bf16 v[124:127], v[84:87], v[228:231], v[124:127]
  ds_read_b128 v[76:79], v15 offset:31744
  v_mul_f32 v49, v100, v49
  v_mfma_f32_16x16x32_bf16 v[120:123], v[84:87], v[224:227], v[120:123]
  s_waitcnt lgkmcnt(4)
  buffer_store_dwordx4 v[96:99], v3, s[8:11], s44 offen offset:0 sc1
  v_mfma_f32_16x16x32_bf16 v[112:115], v[88:91], v[232:235], v[112:115]
  ds_read_b64 v[80:81], v16 offset:512
  v_mul_f32 v50, v100, v50
  v_mfma_f32_16x16x32_bf16 v[116:119], v[88:91], v[236:239], v[116:119]
  v_exp_f32 v48, v48
  v_mfma_f32_16x16x32_bf16 v[124:127], v[92:95], v[236:239], v[124:127]
  ds_read_b64 v[84:85], v16 offset:640
  v_fma_f32 v48, v48, v101, v101
  v_mfma_f32_16x16x32_bf16 v[120:123], v[92:95], v[232:235], v[120:123]
  s_waitcnt lgkmcnt(4)
  buffer_load_dwordx4 a[120:123], v23, s[8:11], s49 offen offset:3072 sc1
  v_mfma_f32_16x16x32_bf16 v[112:115], v[64:67], v[240:243], v[112:115]
  s_waitcnt vmcnt(15)
  s_barrier
  ds_read_b128 v[88:91], v15 offset:32768
  v_mul_f32 v51, v100, v51
  v_mfma_f32_16x16x32_bf16 v[116:119], v[64:67], v[244:247], v[116:119]
  v_exp_f32 v49, v49
  v_mfma_f32_16x16x32_bf16 v[124:127], v[68:71], v[244:247], v[124:127]
  ds_read_b128 v[92:95], v15 offset:33792
  v_fma_f32 v49, v49, v101, v101
  v_mfma_f32_16x16x32_bf16 v[120:123], v[68:71], v[240:243], v[120:123]
  s_waitcnt lgkmcnt(4)
  v_rcp_f32 v48, v48
  v_mfma_f32_16x16x32_bf16 v[112:115], v[72:75], v[248:251], v[112:115]
  ds_read_b128 v[64:67], v15 offset:34816
  v_mul_f32 v48, v48, v56
  v_mfma_f32_16x16x32_bf16 v[116:119], v[72:75], v[252:255], v[116:119]
  v_exp_f32 v50, v50
  v_mfma_f32_16x16x32_bf16 v[124:127], v[76:79], v[252:255], v[124:127]
  ds_read_b128 v[68:71], v15 offset:35840
  v_fma_f32 v50, v50, v101, v101
  v_mfma_f32_16x16x32_bf16 v[120:123], v[76:79], v[248:251], v[120:123]
  s_waitcnt lgkmcnt(4)
  v_rcp_f32 v49, v49
  v_mfma_f32_16x16x32_bf16 v[112:115], v[80:83], v[104:107], v[112:115]
  ds_read_b128 v[72:75], v15 offset:36864
  v_mul_f32 v52, v102, v52
  v_mfma_f32_16x16x32_bf16 v[116:119], v[80:83], v[108:111], v[116:119]
  v_exp_f32 v51, v51
  v_mfma_f32_16x16x32_bf16 v[124:127], v[84:87], v[108:111], v[124:127]
  ds_read_b128 v[76:79], v15 offset:37888
  v_mul_f32 v49, v49, v57
  v_mfma_f32_16x16x32_bf16 v[120:123], v[84:87], v[104:107], v[120:123]
  s_waitcnt lgkmcnt(4)
  v_rcp_f32 v50, v50
  v_mfma_f32_16x16x32_bf16 v[32:35], v[88:91], v[128:131], 0
  s_add_u32 m0, s18, 32768
  ds_read_b128 v[80:83], v15 offset:38912
  v_cvt_pk_bf16_f32 v96, v48, v49
  v_mfma_f32_16x16x32_bf16 v[36:39], v[88:91], v[132:135], 0
  s_add_u32 s17, s17, 28672
  v_exp_f32 v52, v52
  v_mfma_f32_16x16x32_bf16 v[44:47], v[92:95], v[132:135], 0
  ds_read_b128 v[84:87], v15 offset:39936
  v_fma_f32 v51, v51, v101, v101
  v_mfma_f32_16x16x32_bf16 v[40:43], v[92:95], v[128:131], 0
  s_waitcnt lgkmcnt(4)
  buffer_load_dwordx4 v3, s[8:11], s17 offen offset:0 sc1 lds
  v_mfma_f32_16x16x32_bf16 v[32:35], v[64:67], v[136:139], v[32:35]
  ds_read_b128 v[88:91], v15 offset:40960
  v_mul_f32 v53, v102, v53
  v_mfma_f32_16x16x32_bf16 v[36:39], v[64:67], v[140:143], v[36:39]
  v_rcp_f32 v51, v51
  v_mfma_f32_16x16x32_bf16 v[44:47], v[68:71], v[140:143], v[44:47]
  ds_read_b128 v[92:95], v15 offset:41984
  v_mul_f32 v50, v50, v58
  v_mfma_f32_16x16x32_bf16 v[40:43], v[68:71], v[136:139], v[40:43]
  s_waitcnt lgkmcnt(4)
  buffer_load_dwordx4 v3, s[8:11], s17 offen offset:1024 sc1 lds
  v_exp_f32 v53, v53
  v_mfma_f32_16x16x32_bf16 v[32:35], v[72:75], v[144:147], v[32:35]
  ds_read_b128 v[64:67], v15 offset:43008
  v_fma_f32 v52, v52, v103, v103
  v_mfma_f32_16x16x32_bf16 v[36:39], v[72:75], v[148:151], v[36:39]
  v_rcp_f32 v52, v52
  v_mfma_f32_16x16x32_bf16 v[44:47], v[76:79], v[148:151], v[44:47]
  ds_read_b128 v[68:71], v15 offset:44032
  v_mul_f32 v54, v102, v54
  v_mfma_f32_16x16x32_bf16 v[40:43], v[76:79], v[144:147], v[40:43]
  s_waitcnt lgkmcnt(4)
  buffer_load_dwordx4 v3, s[8:11], s17 offen offset:2048 sc1 lds
  v_exp_f32 v54, v54
  v_mfma_f32_16x16x32_bf16 v[32:35], v[80:83], v[152:155], v[32:35]
  ds_read_b128 v[72:75], v15 offset:45056
  v_mul_f32 v51, v51, v59
  v_mfma_f32_16x16x32_bf16 v[36:39], v[80:83], v[156:159], v[36:39]
  v_cvt_pk_bf16_f32 v97, v50, v51
  v_fma_f32 v53, v53, v103, v103
  v_mfma_f32_16x16x32_bf16 v[44:47], v[84:87], v[156:159], v[44:47]
  ds_read_b128 v[76:79], v15 offset:46080
  v_mul_f32 v55, v102, v55
  v_mfma_f32_16x16x32_bf16 v[40:43], v[84:87], v[152:155], v[40:43]
  s_waitcnt lgkmcnt(4)
  buffer_load_dwordx4 v3, s[8:11], s17 offen offset:3072 sc1 lds
  v_rcp_f32 v53, v53
  v_mfma_f32_16x16x32_bf16 v[32:35], v[88:91], v[160:163], v[32:35]
  s_add_u32 m0, s18, 36864
  ds_read_b128 v[80:83], v15 offset:47104
  v_mul_f32 v52, v52, v60
  v_mfma_f32_16x16x32_bf16 v[36:39], v[88:91], v[164:167], v[36:39]
  s_add_u32 s17, s17, 4096
  v_exp_f32 v55, v55
  v_mfma_f32_16x16x32_bf16 v[44:47], v[92:95], v[164:167], v[44:47]
  ds_read_b128 v[84:87], v15 offset:48128
  v_fma_f32 v54, v54, v103, v103
  v_mfma_f32_16x16x32_bf16 v[40:43], v[92:95], v[160:163], v[40:43]
  s_waitcnt lgkmcnt(4)
  buffer_load_dwordx4 v3, s[8:11], s17 offen offset:0 sc1 lds
  v_rcp_f32 v54, v54
  v_mfma_f32_16x16x32_bf16 v[32:35], v[64:67], v[168:171], v[32:35]
  ds_read_b128 v[88:91], v15 offset:49152
  v_mul_f32 v53, v53, v61
  v_mfma_f32_16x16x32_bf16 v[36:39], v[64:67], v[172:175], v[36:39]
  v_cvt_pk_bf16_f32 v98, v52, v53
  v_fma_f32 v55, v55, v103, v103
  v_mfma_f32_16x16x32_bf16 v[44:47], v[68:71], v[172:175], v[44:47]
  ds_read_b128 v[92:95], v15 offset:50176
  v_mul_f32 v54, v54, v62
  v_mfma_f32_16x16x32_bf16 v[40:43], v[68:71], v[168:171], v[40:43]
  s_waitcnt lgkmcnt(4)
  buffer_load_dwordx4 v3, s[8:11], s17 offen offset:1024 sc1 lds
  v_mfma_f32_16x16x32_bf16 v[32:35], v[72:75], v[176:179], v[32:35]
  ds_read_b128 v[64:67], v15 offset:51200
  v_permlane16_swap_b32 v96, v98
  v_mfma_f32_16x16x32_bf16 v[36:39], v[72:75], v[180:183], v[36:39]
  v_rcp_f32 v55, v55
  v_mfma_f32_16x16x32_bf16 v[44:47], v[76:79], v[180:183], v[44:47]
  ds_read_b128 v[68:71], v15 offset:52224
  v_mul_f32 v55, v55, v63
  v_mfma_f32_16x16x32_bf16 v[40:43], v[76:79], v[176:179], v[40:43]
  s_waitcnt lgkmcnt(4)
  buffer_load_dwordx4 v3, s[8:11], s17 offen offset:2048 sc1 lds
  v_mfma_f32_16x16x32_bf16 v[32:35], v[80:83], v[184:187], v[32:35]
  ds_read_b128 v[72:75], v15 offset:53248
  v_cvt_pk_bf16_f32 v99, v54, v55
  v_mfma_f32_16x16x32_bf16 v[36:39], v[80:83], v[188:191], v[36:39]
  s_nop 0
  v_permlane16_swap_b32 v97, v99
  v_mul_f32 v112, v100, v112
  v_mfma_f32_16x16x32_bf16 v[44:47], v[84:87], v[188:191], v[44:47]
  ds_read_b128 v[76:79], v15 offset:54272
  v_mul_f32 v113, v100, v113
  v_mfma_f32_16x16x32_bf16 v[40:43], v[84:87], v[184:187], v[40:43]
  s_waitcnt lgkmcnt(4)
  buffer_store_dwordx4 v[96:99], v3, s[8:11], s44 offen offset:1024 sc1
  v_mfma_f32_16x16x32_bf16 v[32:35], v[88:91], v[192:195], v[32:35]
  ds_read_b128 v[80:83], v15 offset:55296
  v_mul_f32 v114, v100, v114
  v_mfma_f32_16x16x32_bf16 v[36:39], v[88:91], v[196:199], v[36:39]
  v_exp_f32 v112, v112
  v_mfma_f32_16x16x32_bf16 v[44:47], v[92:95], v[196:199], v[44:47]
  ds_read_b128 v[84:87], v15 offset:56320
  v_fma_f32 v112, v112, v101, v101
  v_mfma_f32_16x16x32_bf16 v[40:43], v[92:95], v[192:195], v[40:43]
  s_waitcnt lgkmcnt(4)
  buffer_load_dwordx4 v3, s[8:11], s17 offen offset:3072 sc1 lds
  v_mfma_f32_16x16x32_bf16 v[32:35], v[64:67], v[200:203], v[32:35]
  ds_read_b128 v[88:91], v15 offset:57344
  v_mul_f32 v115, v100, v115
  v_mfma_f32_16x16x32_bf16 v[36:39], v[64:67], v[204:207], v[36:39]
  v_exp_f32 v113, v113
  v_mfma_f32_16x16x32_bf16 v[44:47], v[68:71], v[204:207], v[44:47]
  ds_read_b128 v[92:95], v15 offset:58368
  v_fma_f32 v113, v113, v101, v101
  v_mfma_f32_16x16x32_bf16 v[40:43], v[68:71], v[200:203], v[40:43]
  s_waitcnt lgkmcnt(4)
  buffer_load_dwordx4 a[124:127], v23, s[8:11], s49 offen offset:3584 sc1
  v_mfma_f32_16x16x32_bf16 v[32:35], v[72:75], v[208:211], v[32:35]
  ds_read_b128 v[64:67], v15 offset:59392
  v_mul_f32 v116, v102, v116
  v_mfma_f32_16x16x32_bf16 v[36:39], v[72:75], v[212:215], v[36:39]
  v_rcp_f32 v112, v112
  v_mfma_f32_16x16x32_bf16 v[44:47], v[76:79], v[212:215], v[44:47]
  ds_read_b128 v[68:71], v15 offset:60416
  v_mul_f32 v112, v112, v120
  v_mfma_f32_16x16x32_bf16 v[40:43], v[76:79], v[208:211], v[40:43]
  s_waitcnt lgkmcnt(4)
  s_add_u32 s48, s48, 4096
  buffer_load_dwordx4 a[128:131], v23, s[8:11], s48 offen offset:0 sc1
  v_mfma_f32_16x16x32_bf16 v[32:35], v[80:83], v[216:219], v[32:35]
  ds_read_b128 v[72:75], v15 offset:61440
  v_mul_f32 v117, v102, v117
  v_mfma_f32_16x16x32_bf16 v[36:39], v[80:83], v[220:223], v[36:39]
  v_exp_f32 v114, v114
  v_mfma_f32_16x16x32_bf16 v[44:47], v[84:87], v[220:223], v[44:47]
  ds_read_b128 v[76:79], v15 offset:62464
  v_fma_f32 v114, v114, v101, v101
  v_mfma_f32_16x16x32_bf16 v[40:43], v[84:87], v[216:219], v[40:43]
  s_waitcnt lgkmcnt(4)
  buffer_load_dwordx4 a[132:135], v23, s[8:11], s48 offen offset:512 sc1
  v_mfma_f32_16x16x32_bf16 v[32:35], v[88:91], v[224:227], v[32:35]
  ds_read_b128 v[80:83], v15 offset:63488
  v_mul_f32 v118, v102, v118
  v_mfma_f32_16x16x32_bf16 v[36:39], v[88:91], v[228:231], v[36:39]
  v_rcp_f32 v113, v113
  v_mfma_f32_16x16x32_bf16 v[44:47], v[92:95], v[228:231], v[44:47]
  ds_read_b128 v[84:87], v15 offset:64512
  v_mul_f32 v113, v113, v121
  v_mfma_f32_16x16x32_bf16 v[40:43], v[92:95], v[224:227], v[40:43]
  s_waitcnt lgkmcnt(4)
  buffer_load_dwordx4 a[136:139], v23, s[8:11], s48 offen offset:1024 sc1
  v_mfma_f32_16x16x32_bf16 v[32:35], v[64:67], v[232:235], v[32:35]
  ds_read_b64 v[88:89], v16 offset:768
  v_cvt_pk_bf16_f32 v96, v112, v113
  v_mfma_f32_16x16x32_bf16 v[36:39], v[64:67], v[236:239], v[36:39]
  v_exp_f32 v115, v115
  v_mfma_f32_16x16x32_bf16 v[44:47], v[68:71], v[236:239], v[44:47]
  ds_read_b64 v[92:93], v16 offset:896
  v_fma_f32 v115, v115, v101, v101
  v_mfma_f32_16x16x32_bf16 v[40:43], v[68:71], v[232:235], v[40:43]
  s_waitcnt lgkmcnt(4)
  buffer_load_dwordx4 a[140:143], v23, s[8:11], s48 offen offset:1536 sc1
  v_mfma_f32_16x16x32_bf16 v[32:35], v[72:75], v[240:243], v[32:35]
  s_waitcnt vmcnt(16)
  s_barrier
  ds_read_b128 v[64:67], v3 offset:0
  v_mul_f32 v119, v102, v119
  v_mfma_f32_16x16x32_bf16 v[36:39], v[72:75], v[244:247], v[36:39]
  v_rcp_f32 v114, v114
  v_mfma_f32_16x16x32_bf16 v[44:47], v[76:79], v[244:247], v[44:47]
  ds_read_b128 v[68:71], v3 offset:1024
  v_mul_f32 v114, v114, v122
  v_mfma_f32_16x16x32_bf16 v[40:43], v[76:79], v[240:243], v[40:43]
  s_waitcnt lgkmcnt(4)
  s_add_u32 s49, s49, 4096
  buffer_load_dwordx4 a[144:147], v23, s[8:11], s49 offen offset:0 sc1
  v_mfma_f32_16x16x32_bf16 v[32:35], v[80:83], v[248:251], v[32:35]
  ds_read_b128 v[72:75], v3 offset:2048
  v_mfma_f32_16x16x32_bf16 v[36:39], v[80:83], v[252:255], v[36:39]
  v_exp_f32 v116, v116
  v_mfma_f32_16x16x32_bf16 v[44:47], v[84:87], v[252:255], v[44:47]
  ds_read_b128 v[76:79], v3 offset:3072
  v_fma_f32 v116, v116, v103, v103
  v_mfma_f32_16x16x32_bf16 v[40:43], v[84:87], v[248:251], v[40:43]
  s_waitcnt lgkmcnt(4)
  v_rcp_f32 v115, v115
  v_mfma_f32_16x16x32_bf16 v[32:35], v[88:91], v[104:107], v[32:35]
  ds_read_b128 v[80:83], v3 offset:4096
  v_mul_f32 v115, v115, v123
  v_mfma_f32_16x16x32_bf16 v[36:39], v[88:91], v[108:111], v[36:39]
  v_exp_f32 v117, v117
  v_mfma_f32_16x16x32_bf16 v[44:47], v[92:95], v[108:111], v[44:47]
  ds_read_b128 v[84:87], v3 offset:5120
  v_cvt_pk_bf16_f32 v97, v114, v115
  v_mfma_f32_16x16x32_bf16 v[40:43], v[92:95], v[104:107], v[40:43]
  s_waitcnt lgkmcnt(4)
  v_rcp_f32 v116, v116
  v_mfma_f32_16x16x32_bf16 v[48:51], v[64:67], v[128:131], 0
  s_add_u32 m0, s18, 65536
  ds_read_b128 v[88:91], v3 offset:6144
  v_fma_f32 v117, v117, v103, v103
  v_mfma_f32_16x16x32_bf16 v[52:55], v[64:67], v[132:135], 0
  s_add_u32 s17, s17, 28672
  v_exp_f32 v118, v118
  v_mfma_f32_16x16x32_bf16 v[60:63], v[68:71], v[132:135], 0
  ds_read_b128 v[92:95], v3 offset:7168
  v_mul_f32 v116, v116, v124
  v_mfma_f32_16x16x32_bf16 v[56:59], v[68:71], v[128:131], 0
  s_waitcnt lgkmcnt(4)
  buffer_load_dwordx4 v3, s[8:11], s17 offen offset:0 sc1 lds
  v_mfma_f32_16x16x32_bf16 v[48:51], v[72:75], v[136:139], v[48:51]
  ds_read_b128 v[64:67], v3 offset:8192
  v_fma_f32 v118, v118, v103, v103
  v_mfma_f32_16x16x32_bf16 v[52:55], v[72:75], v[140:143], v[52:55]
  v_rcp_f32 v117, v117
  v_mfma_f32_16x16x32_bf16 v[60:63], v[76:79], v[140:143], v[60:63]
  ds_read_b128 v[68:71], v3 offset:9216
  v_mul_f32 v117, v117, v125
  v_mfma_f32_16x16x32_bf16 v[56:59], v[76:79], v[136:139], v[56:59]
  s_waitcnt lgkmcnt(4)
  buffer_load_dwordx4 v3, s[8:11], s17 offen offset:1024 sc1 lds
  v_exp_f32 v119, v119
  v_mfma_f32_16x16x32_bf16 v[48:51], v[80:83], v[144:147], v[48:51]
  ds_read_b128 v[72:75], v3 offset:10240
  v_cvt_pk_bf16_f32 v98, v116, v117
  v_mfma_f32_16x16x32_bf16 v[52:55], v[80:83], v[148:151], v[52:55]
  v_rcp_f32 v118, v118
  v_mfma_f32_16x16x32_bf16 v[60:63], v[84:87], v[148:151], v[60:63]
  ds_read_b128 v[76:79], v3 offset:11264
  v_fma_f32 v119, v119, v103, v103
  v_mfma_f32_16x16x32_bf16 v[56:59], v[84:87], v[144:147], v[56:59]
  s_waitcnt lgkmcnt(4)
  s_waitcnt vmcnt(9)
  s_mov_b32 exec_hi, 0
  buffer_store_dword v19, v10, s[8:11], s29 offen sc1
  s_mov_b32 exec_hi, -1
  v_mfma_f32_16x16x32_bf16 v[48:51], v[88:91], v[152:155], v[48:51]
  ds_read_b128 v[80:83], v3 offset:12288
  v_mul_f32 v118, v118, v126
  v_mfma_f32_16x16x32_bf16 v[52:55], v[88:91], v[156:159], v[52:55]
  v_rcp_f32 v119, v119
  v_mfma_f32_16x16x32_bf16 v[60:63], v[92:95], v[156:159], v[60:63]
  ds_read_b128 v[84:87], v3 offset:13312
  v_mul_f32 v119, v119, v127
  v_mfma_f32_16x16x32_bf16 v[56:59], v[92:95], v[152:155], v[56:59]
  s_waitcnt lgkmcnt(4)
  buffer_load_dwordx4 v3, s[8:11], s17 offen offset:2048 sc1 lds
  v_mfma_f32_16x16x32_bf16 v[48:51], v[64:67], v[160:163], v[48:51]
  ds_read_b128 v[88:91], v3 offset:14336
  v_cvt_pk_bf16_f32 v99, v118, v119
  v_mfma_f32_16x16x32_bf16 v[52:55], v[64:67], v[164:167], v[52:55]
  v_permlane16_swap_b32 v96, v98
  v_permlane16_swap_b32 v97, v99
  v_mfma_f32_16x16x32_bf16 v[60:63], v[68:71], v[164:167], v[60:63]
  ds_read_b128 v[92:95], v3 offset:15360
  v_mul_f32 v32, v100, v32
  v_mfma_f32_16x16x32_bf16 v[56:59], v[68:71], v[160:163], v[56:59]
  s_waitcnt lgkmcnt(4)
  buffer_store_dwordx4 v[96:99], v3, s[8:11], s44 offen offset:2048 sc1
  v_mfma_f32_16x16x32_bf16 v[48:51], v[72:75], v[168:171], v[48:51]
  ds_read_b128 v[64:67], v3 offset:16384
  v_mul_f32 v33, v100, v33
  v_mfma_f32_16x16x32_bf16 v[52:55], v[72:75], v[172:175], v[52:55]
  v_exp_f32 v32, v32
  v_mfma_f32_16x16x32_bf16 v[60:63], v[76:79], v[172:175], v[60:63]
  ds_read_b128 v[68:71], v3 offset:17408
  v_fma_f32 v32, v32, v101, v101
  v_mfma_f32_16x16x32_bf16 v[56:59], v[76:79], v[168:171], v[56:59]
  s_waitcnt lgkmcnt(4)
  buffer_load_dwordx4 v3, s[8:11], s17 offen offset:3072 sc1 lds
  v_mfma_f32_16x16x32_bf16 v[48:51], v[80:83], v[176:179], v[48:51]
  s_add_u32 m0, s18, 69632
  ds_read_b128 v[72:75], v3 offset:18432
  v_mul_f32 v34, v100, v34
  v_mfma_f32_16x16x32_bf16 v[52:55], v[80:83], v[180:183], v[52:55]
  s_add_u32 s17, s17, 4096
  v_exp_f32 v33, v33
  v_mfma_f32_16x16x32_bf16 v[60:63], v[84:87], v[180:183], v[60:63]
  ds_read_b128 v[76:79], v3 offset:19456
  v_fma_f32 v33, v33, v101, v101
  v_mfma_f32_16x16x32_bf16 v[56:59], v[84:87], v[176:179], v[56:59]
  s_waitcnt lgkmcnt(4)
  buffer_load_dwordx4 v3, s[8:11], s17 offen offset:0 sc1 lds
  v_mfma_f32_16x16x32_bf16 v[48:51], v[88:91], v[184:187], v[48:51]
  ds_read_b128 v[80:83], v3 offset:20480
  v_mul_f32 v35, v100, v35
  v_mfma_f32_16x16x32_bf16 v[52:55], v[88:91], v[188:191], v[52:55]
  v_rcp_f32 v32, v32
  v_mfma_f32_16x16x32_bf16 v[60:63], v[92:95], v[188:191], v[60:63]
  ds_read_b128 v[84:87], v3 offset:21504
  v_mul_f32 v32, v32, v40
  v_mfma_f32_16x16x32_bf16 v[56:59], v[92:95], v[184:187], v[56:59]
  s_waitcnt lgkmcnt(4)
  buffer_load_dwordx4 v3, s[8:11], s17 offen offset:1024 sc1 lds
  v_mfma_f32_16x16x32_bf16 v[48:51], v[64:67], v[192:195], v[48:51]
  ds_read_b128 v[88:91], v3 offset:22528
  v_mul_f32 v36, v102, v36
  v_mfma_f32_16x16x32_bf16 v[52:55], v[64:67], v[196:199], v[52:55]
  v_exp_f32 v34, v34
  v_mfma_f32_16x16x32_bf16 v[60:63], v[68:71], v[196:199], v[60:63]
  ds_read_b128 v[92:95], v3 offset:23552
  v_fma_f32 v34, v34, v101, v101
  v_mfma_f32_16x16x32_bf16 v[56:59], v[68:71], v[192:195], v[56:59]
  s_waitcnt lgkmcnt(4)
  buffer_load_dwordx4 v3, s[8:11], s17 offen offset:2048 sc1 lds
  v_mfma_f32_16x16x32_bf16 v[48:51], v[72:75], v[200:203], v[48:51]
  ds_read_b128 v[64:67], v3 offset:24576
  v_mul_f32 v37, v102, v37
  v_mfma_f32_16x16x32_bf16 v[52:55], v[72:75], v[204:207], v[52:55]
  v_rcp_f32 v33, v33
  v_mfma_f32_16x16x32_bf16 v[60:63], v[76:79], v[204:207], v[60:63]
  ds_read_b128 v[68:71], v3 offset:25600
  v_mul_f32 v33, v33, v41
  v_mfma_f32_16x16x32_bf16 v[56:59], v[76:79], v[200:203], v[56:59]
  s_waitcnt lgkmcnt(4)
  buffer_load_dwordx4 v3, s[8:11], s17 offen offset:3072 sc1 lds
  v_mfma_f32_16x16x32_bf16 v[48:51], v[80:83], v[208:211], v[48:51]
  ds_read_b128 v[72:75], v3 offset:26624
  v_cvt_pk_bf16_f32 v96, v32, v33
  v_mfma_f32_16x16x32_bf16 v[52:55], v[80:83], v[212:215], v[52:55]
  v_exp_f32 v35, v35
  v_mfma_f32_16x16x32_bf16 v[60:63], v[84:87], v[212:215], v[60:63]
  ds_read_b128 v[76:79], v3 offset:27648
  v_fma_f32 v35, v35, v101, v101
  v_mfma_f32_16x16x32_bf16 v[56:59], v[84:87], v[208:211], v[56:59]
  s_waitcnt lgkmcnt(4)
  buffer_load_dwordx4 a[148:151], v23, s[8:11], s49 offen offset:512 sc1
  v_mfma_f32_16x16x32_bf16 v[48:51], v[88:91], v[216:219], v[48:51]
  ds_read_b128 v[80:83], v3 offset:28672
  v_mul_f32 v38, v102, v38
  v_mfma_f32_16x16x32_bf16 v[52:55], v[88:91], v[220:223], v[52:55]
  v_rcp_f32 v34, v34
  v_mfma_f32_16x16x32_bf16 v[60:63], v[92:95], v[220:223], v[60:63]
  ds_read_b128 v[84:87], v3 offset:29696
  v_mul_f32 v34, v34, v42
  v_mfma_f32_16x16x32_bf16 v[56:59], v[92:95], v[216:219], v[56:59]
  s_waitcnt lgkmcnt(4)
  buffer_load_dwordx4 a[152:155], v23, s[8:11], s49 offen offset:1024 sc1
  v_mfma_f32_16x16x32_bf16 v[48:51], v[64:67], v[224:227], v[48:51]
  ds_read_b128 v[88:91], v3 offset:30720
  v_mul_f32 v39, v102, v39
  v_mfma_f32_16x16x32_bf16 v[52:55], v[64:67], v[228:231], v[52:55]
  v_exp_f32 v36, v36
  v_mfma_f32_16x16x32_bf16 v[60:63], v[68:71], v[228:231], v[60:63]
  ds_read_b128 v[92:95], v3 offset:31744
  v_fma_f32 v36, v36, v103, v103
  v_mfma_f32_16x16x32_bf16 v[56:59], v[68:71], v[224:227], v[56:59]
  s_waitcnt lgkmcnt(4)
  buffer_load_dwordx4 a[156:159], v23, s[8:11], s49 offen offset:1536 sc1
  v_mfma_f32_16x16x32_bf16 v[48:51], v[72:75], v[232:235], v[48:51]
  ds_read_b64 v[64:65], v16 offset:1024
  v_mfma_f32_16x16x32_bf16 v[52:55], v[72:75], v[236:239], v[52:55]
  v_rcp_f32 v35, v35
  v_mfma_f32_16x16x32_bf16 v[60:63], v[76:79], v[236:239], v[60:63]
  ds_read_b64 v[68:69], v16 offset:1152
  v_mul_f32 v35, v35, v43
  v_mfma_f32_16x16x32_bf16 v[56:59], v[76:79], v[232:235], v[56:59]
  s_waitcnt lgkmcnt(4)
  buffer_load_dwordx4 a[160:163], v23, s[8:11], s48 offen offset:2048 sc1
  v_mfma_f32_16x16x32_bf16 v[48:51], v[80:83], v[240:243], v[48:51]
  s_waitcnt vmcnt(20)
  s_barrier
  ds_read_b128 v[72:75], v3 offset:32768
  v_cvt_pk_bf16_f32 v97, v34, v35
  v_mfma_f32_16x16x32_bf16 v[52:55], v[80:83], v[244:247], v[52:55]
  v_exp_f32 v37, v37
  v_mfma_f32_16x16x32_bf16 v[60:63], v[84:87], v[244:247], v[60:63]
  ds_read_b128 v[76:79], v3 offset:33792
  v_fma_f32 v37, v37, v103, v103
  v_mfma_f32_16x16x32_bf16 v[56:59], v[84:87], v[240:243], v[56:59]
  s_waitcnt lgkmcnt(4)
  buffer_load_dwordx4 a[164:167], v23, s[8:11], s48 offen offset:2560 sc1
  v_mfma_f32_16x16x32_bf16 v[48:51], v[88:91], v[248:251], v[48:51]
  ds_read_b128 v[80:83], v3 offset:34816
  v_mfma_f32_16x16x32_bf16 v[52:55], v[88:91], v[252:255], v[52:55]
  v_rcp_f32 v36, v36
  v_mfma_f32_16x16x32_bf16 v[60:63], v[92:95], v[252:255], v[60:63]
  ds_read_b128 v[84:87], v3 offset:35840
  v_mul_f32 v36, v36, v44
  v_mfma_f32_16x16x32_bf16 v[56:59], v[92:95], v[248:251], v[56:59]
  s_waitcnt lgkmcnt(4)
  buffer_load_dwordx4 a[168:171], v23, s[8:11], s48 offen offset:3072 sc1
  v_mfma_f32_16x16x32_bf16 v[48:51], v[64:67], v[104:107], v[48:51]
  ds_read_b128 v[88:91], v3 offset:36864
  v_mfma_f32_16x16x32_bf16 v[52:55], v[64:67], v[108:111], v[52:55]
  v_exp_f32 v38, v38
  v_mfma_f32_16x16x32_bf16 v[60:63], v[68:71], v[108:111], v[60:63]
  ds_read_b128 v[92:95], v3 offset:37888
  v_fma_f32 v38, v38, v103, v103
  v_mfma_f32_16x16x32_bf16 v[56:59], v[68:71], v[104:107], v[56:59]
  s_waitcnt lgkmcnt(4)
  v_rcp_f32 v37, v37
  v_mfma_f32_16x16x32_bf16 v[112:115], v[72:75], v[128:131], 0
  ds_read_b128 v[64:67], v3 offset:38912
  v_mul_f32 v37, v37, v45
  v_mfma_f32_16x16x32_bf16 v[116:119], v[72:75], v[132:135], 0
  v_exp_f32 v39, v39
  v_mfma_f32_16x16x32_bf16 v[124:127], v[76:79], v[132:135], 0
  ds_read_b128 v[68:71], v3 offset:39936
  v_cvt_pk_bf16_f32 v98, v36, v37
  v_mfma_f32_16x16x32_bf16 v[120:123], v[76:79], v[128:131], 0
  s_waitcnt lgkmcnt(4)
  buffer_load_dwordx4 a[172:175], v23, s[8:11], s48 offen offset:3584 sc1
  v_mfma_f32_16x16x32_bf16 v[112:115], v[80:83], v[136:139], v[112:115]
  ds_read_b128 v[72:75], v3 offset:40960
  v_fma_f32 v39, v39, v103, v103
  v_mfma_f32_16x16x32_bf16 v[116:119], v[80:83], v[140:143], v[116:119]
  v_rcp_f32 v38, v38
  v_mfma_f32_16x16x32_bf16 v[124:127], v[84:87], v[140:143], v[124:127]
  ds_read_b128 v[76:79], v3 offset:41984
  v_mul_f32 v38, v38, v46
  v_mfma_f32_16x16x32_bf16 v[120:123], v[84:87], v[136:139], v[120:123]
  s_waitcnt lgkmcnt(4)
  buffer_load_dwordx4 a[176:179], v23, s[8:11], s49 offen offset:2048 sc1
  v_mfma_f32_16x16x32_bf16 v[112:115], v[88:91], v[144:147], v[112:115]
  ds_read_b128 v[80:83], v3 offset:43008
  v_permlane16_swap_b32 v96, v98
  v_mfma_f32_16x16x32_bf16 v[116:119], v[88:91], v[148:151], v[116:119]
  v_rcp_f32 v39, v39
  v_mfma_f32_16x16x32_bf16 v[124:127], v[92:95], v[148:151], v[124:127]
  ds_read_b128 v[84:87], v3 offset:44032
  v_mul_f32 v39, v39, v47
  v_mfma_f32_16x16x32_bf16 v[120:123], v[92:95], v[144:147], v[120:123]
  s_waitcnt lgkmcnt(4)
  buffer_load_dwordx4 a[180:183], v23, s[8:11], s49 offen offset:2560 sc1
  v_mfma_f32_16x16x32_bf16 v[112:115], v[64:67], v[152:155], v[112:115]
  ds_read_b128 v[88:91], v3 offset:45056
  v_cvt_pk_bf16_f32 v99, v38, v39
  v_mfma_f32_16x16x32_bf16 v[116:119], v[64:67], v[156:159], v[116:119]
  s_nop 0
  v_permlane16_swap_b32 v97, v99
  v_mul_f32 v48, v100, v48
  v_mfma_f32_16x16x32_bf16 v[124:127], v[68:71], v[156:159], v[124:127]
  ds_read_b128 v[92:95], v3 offset:46080
  v_mul_f32 v49, v100, v49
  v_mfma_f32_16x16x32_bf16 v[120:123], v[68:71], v[152:155], v[120:123]
  s_waitcnt lgkmcnt(4)
  buffer_store_dwordx4 v[96:99], v3, s[8:11], s44 offen offset:3072 sc1
  v_mfma_f32_16x16x32_bf16 v[112:115], v[72:75], v[160:163], v[112:115]
  ds_read_b128 v[64:67], v3 offset:47104
  v_mul_f32 v50, v100, v50
  v_mfma_f32_16x16x32_bf16 v[116:119], v[72:75], v[164:167], v[116:119]
  v_exp_f32 v48, v48
  v_mfma_f32_16x16x32_bf16 v[124:127], v[76:79], v[164:167], v[124:127]
  ds_read_b128 v[68:71], v3 offset:48128
  v_fma_f32 v48, v48, v101, v101
  v_mfma_f32_16x16x32_bf16 v[120:123], v[76:79], v[160:163], v[120:123]
  s_waitcnt lgkmcnt(4)
  buffer_load_dword v9, v8, s[8:11], s30 offen sc1
  v_mfma_f32_16x16x32_bf16 v[112:115], v[80:83], v[168:171], v[112:115]
  ds_read_b128 v[72:75], v3 offset:49152
  v_mul_f32 v51, v100, v51
  v_mfma_f32_16x16x32_bf16 v[116:119], v[80:83], v[172:175], v[116:119]
  v_exp_f32 v49, v49
  v_mfma_f32_16x16x32_bf16 v[124:127], v[84:87], v[172:175], v[124:127]
  ds_read_b128 v[76:79], v3 offset:50176
  v_fma_f32 v49, v49, v101, v101
  v_mfma_f32_16x16x32_bf16 v[120:123], v[84:87], v[168:171], v[120:123]
  s_waitcnt lgkmcnt(4)
  buffer_load_dwordx4 a[184:187], v23, s[8:11], s49 offen offset:3072 sc1
  v_mfma_f32_16x16x32_bf16 v[112:115], v[88:91], v[176:179], v[112:115]
  ds_read_b128 v[80:83], v3 offset:51200
  v_mul_f32 v52, v102, v52
  v_mfma_f32_16x16x32_bf16 v[116:119], v[88:91], v[180:183], v[116:119]
  v_rcp_f32 v48, v48
  v_mfma_f32_16x16x32_bf16 v[124:127], v[92:95], v[180:183], v[124:127]
  ds_read_b128 v[84:87], v3 offset:52224
  v_mul_f32 v48, v48, v56
  v_mfma_f32_16x16x32_bf16 v[120:123], v[92:95], v[176:179], v[120:123]
  s_waitcnt lgkmcnt(4)
  buffer_load_dwordx4 a[188:191], v23, s[8:11], s49 offen offset:3584 sc1
  v_mfma_f32_16x16x32_bf16 v[112:115], v[64:67], v[184:187], v[112:115]
  ds_read_b128 v[88:91], v3 offset:53248
  v_mul_f32 v53, v102, v53
  v_mfma_f32_16x16x32_bf16 v[116:119], v[64:67], v[188:191], v[116:119]
  v_exp_f32 v50, v50
  v_mfma_f32_16x16x32_bf16 v[124:127], v[68:71], v[188:191], v[124:127]
  ds_read_b128 v[92:95], v3 offset:54272
  v_fma_f32 v50, v50, v101, v101
  v_mfma_f32_16x16x32_bf16 v[120:123], v[68:71], v[184:187], v[120:123]
  s_waitcnt lgkmcnt(4)
  s_add_u32 s48, s48, 4096
  buffer_load_dwordx4 a[192:195], v23, s[8:11], s48 offen offset:0 sc1
  v_mfma_f32_16x16x32_bf16 v[112:115], v[72:75], v[192:195], v[112:115]
  ds_read_b128 v[64:67], v3 offset:55296
  v_mul_f32 v54, v102, v54
  v_mfma_f32_16x16x32_bf16 v[116:119], v[72:75], v[196:199], v[116:119]
  v_rcp_f32 v49, v49
  v_mfma_f32_16x16x32_bf16 v[124:127], v[76:79], v[196:199], v[124:127]
  ds_read_b128 v[68:71], v3 offset:56320
  v_mul_f32 v49, v49, v57
  v_mfma_f32_16x16x32_bf16 v[120:123], v[76:79], v[192:195], v[120:123]
  s_waitcnt lgkmcnt(4)
  buffer_load_dwordx4 a[196:199], v23, s[8:11], s48 offen offset:512 sc1
  v_mfma_f32_16x16x32_bf16 v[112:115], v[80:83], v[200:203], v[112:115]
  ds_read_b128 v[72:75], v3 offset:57344
  v_cvt_pk_bf16_f32 v96, v48, v49
  v_mfma_f32_16x16x32_bf16 v[116:119], v[80:83], v[204:207], v[116:119]
  v_exp_f32 v51, v51
  v_mfma_f32_16x16x32_bf16 v[124:127], v[84:87], v[204:207], v[124:127]
  ds_read_b128 v[76:79], v3 offset:58368
  v_fma_f32 v51, v51, v101, v101
  v_mfma_f32_16x16x32_bf16 v[120:123], v[84:87], v[200:203], v[120:123]
  s_waitcnt lgkmcnt(4)
  buffer_load_dwordx4 a[200:203], v23, s[8:11], s48 offen offset:1024 sc1
  v_mfma_f32_16x16x32_bf16 v[112:115], v[88:91], v[208:211], v[112:115]
  ds_read_b128 v[80:83], v3 offset:59392
  v_mul_f32 v55, v102, v55
  v_mfma_f32_16x16x32_bf16 v[116:119], v[88:91], v[212:215], v[116:119]
  v_rcp_f32 v50, v50
  v_mfma_f32_16x16x32_bf16 v[124:127], v[92:95], v[212:215], v[124:127]
  ds_read_b128 v[84:87], v3 offset:60416
  v_mul_f32 v50, v50, v58
  v_mfma_f32_16x16x32_bf16 v[120:123], v[92:95], v[208:211], v[120:123]
  s_waitcnt lgkmcnt(4)
  buffer_load_dwordx4 a[204:207], v23, s[8:11], s48 offen offset:1536 sc1
  v_mfma_f32_16x16x32_bf16 v[112:115], v[64:67], v[216:219], v[112:115]
  ds_read_b128 v[88:91], v3 offset:61440
  v_mfma_f32_16x16x32_bf16 v[116:119], v[64:67], v[220:223], v[116:119]
  v_exp_f32 v52, v52
  v_mfma_f32_16x16x32_bf16 v[124:127], v[68:71], v[220:223], v[124:127]
  ds_read_b128 v[92:95], v3 offset:62464
  v_fma_f32 v52, v52, v103, v103
  v_mfma_f32_16x16x32_bf16 v[120:123], v[68:71], v[216:219], v[120:123]
  s_waitcnt lgkmcnt(4)
  s_add_u32 s49, s49, 4096
  buffer_load_dwordx4 a[208:211], v23, s[8:11], s49 offen offset:0 sc1
  v_mfma_f32_16x16x32_bf16 v[112:115], v[72:75], v[224:227], v[112:115]
  ds_read_b128 v[64:67], v3 offset:63488
  v_mfma_f32_16x16x32_bf16 v[116:119], v[72:75], v[228:231], v[116:119]
  v_rcp_f32 v51, v51
  v_mfma_f32_16x16x32_bf16 v[124:127], v[76:79], v[228:231], v[124:127]
  ds_read_b128 v[68:71], v3 offset:64512
  v_mul_f32 v51, v51, v59
  v_mfma_f32_16x16x32_bf16 v[120:123], v[76:79], v[224:227], v[120:123]
  s_waitcnt lgkmcnt(4)
  buffer_load_dwordx4 a[212:215], v23, s[8:11], s49 offen offset:512 sc1
  v_mfma_f32_16x16x32_bf16 v[112:115], v[80:83], v[232:235], v[112:115]
  ds_read_b64 v[72:73], v16 offset:1280
  v_cvt_pk_bf16_f32 v97, v50, v51
  v_mfma_f32_16x16x32_bf16 v[116:119], v[80:83], v[236:239], v[116:119]
  v_exp_f32 v53, v53
  v_mfma_f32_16x16x32_bf16 v[124:127], v[84:87], v[236:239], v[124:127]
  ds_read_b64 v[76:77], v16 offset:1408
  v_fma_f32 v53, v53, v103, v103
  v_mfma_f32_16x16x32_bf16 v[120:123], v[84:87], v[232:235], v[120:123]
  s_waitcnt lgkmcnt(4)
  buffer_load_dwordx4 a[216:219], v23, s[8:11], s49 offen offset:1024 sc1
  v_mfma_f32_16x16x32_bf16 v[112:115], v[88:91], v[240:243], v[112:115]
  s_waitcnt vmcnt(20)
  s_barrier
  ds_read_b128 v[80:83], v15 offset:0
  v_mfma_f32_16x16x32_bf16 v[116:119], v[88:91], v[244:247], v[116:119]
  v_rcp_f32 v52, v52
  v_mfma_f32_16x16x32_bf16 v[124:127], v[92:95], v[244:247], v[124:127]
  ds_read_b128 v[84:87], v15 offset:1024
  v_mul_f32 v52, v52, v60
  v_mfma_f32_16x16x32_bf16 v[120:123], v[92:95], v[240:243], v[120:123]
  s_waitcnt lgkmcnt(4)
  buffer_load_dwordx4 a[220:223], v23, s[8:11], s49 offen offset:1536 sc1
  v_mfma_f32_16x16x32_bf16 v[112:115], v[64:67], v[248:251], v[112:115]
  ds_read_b128 v[88:91], v15 offset:2048
  v_mfma_f32_16x16x32_bf16 v[116:119], v[64:67], v[252:255], v[116:119]
  v_exp_f32 v54, v54
  v_mfma_f32_16x16x32_bf16 v[124:127], v[68:71], v[252:255], v[124:127]
  ds_read_b128 v[92:95], v15 offset:3072
  v_fma_f32 v54, v54, v103, v103
  v_mfma_f32_16x16x32_bf16 v[120:123], v[68:71], v[248:251], v[120:123]
  s_waitcnt lgkmcnt(4)
  v_rcp_f32 v53, v53
  v_mfma_f32_16x16x32_bf16 v[112:115], v[72:75], v[104:107], v[112:115]
  ds_read_b128 v[64:67], v15 offset:4096
  v_mul_f32 v53, v53, v61
  v_mfma_f32_16x16x32_bf16 v[116:119], v[72:75], v[108:111], v[116:119]
  v_exp_f32 v55, v55
  v_mfma_f32_16x16x32_bf16 v[124:127], v[76:79], v[108:111], v[124:127]
  ds_read_b128 v[68:71], v15 offset:5120
  v_cvt_pk_bf16_f32 v98, v52, v53
  v_mfma_f32_16x16x32_bf16 v[120:123], v[76:79], v[104:107], v[120:123]
  s_waitcnt lgkmcnt(4)
  v_rcp_f32 v54, v54
  v_mfma_f32_16x16x32_bf16 v[32:35], v[80:83], v[128:131], 0
  ds_read_b128 v[72:75], v15 offset:6144
  v_fma_f32 v55, v55, v103, v103
  v_mfma_f32_16x16x32_bf16 v[36:39], v[80:83], v[132:135], 0
  v_rcp_f32 v55, v55
  v_mfma_f32_16x16x32_bf16 v[44:47], v[84:87], v[132:135], 0
  ds_read_b128 v[76:79], v15 offset:7168
  v_mul_f32 v54, v54, v62
  v_mfma_f32_16x16x32_bf16 v[40:43], v[84:87], v[128:131], 0
  s_waitcnt lgkmcnt(4)
  s_waitcnt vmcnt(10)
  v_cmp_ne_u32 vcc, s50, v9
  v_mfma_f32_16x16x32_bf16 v[32:35], v[88:91], v[136:139], v[32:35]
  ds_read_b128 v[80:83], v15 offset:8192
  v_mul_f32 v55, v55, v63
  v_mfma_f32_16x16x32_bf16 v[36:39], v[88:91], v[140:143], v[36:39]
  v_cvt_pk_bf16_f32 v99, v54, v55
  v_permlane16_swap_b32 v96, v98
  v_mfma_f32_16x16x32_bf16 v[44:47], v[92:95], v[140:143], v[44:47]
  ds_read_b128 v[84:87], v15 offset:9216
  v_permlane16_swap_b32 v97, v99
  v_mfma_f32_16x16x32_bf16 v[40:43], v[92:95], v[136:139], v[40:43]
  s_waitcnt lgkmcnt(4)
  buffer_store_dwordx4 v[96:99], v3, s[8:11], s45 offen offset:0 sc1
  v_mfma_f32_16x16x32_bf16 v[32:35], v[64:67], v[144:147], v[32:35]
  ds_read_b128 v[88:91], v15 offset:10240
  v_mul_f32 v112, v100, v112
  v_mfma_f32_16x16x32_bf16 v[36:39], v[64:67], v[148:151], v[36:39]
  v_exp_f32 v112, v112
  v_mfma_f32_16x16x32_bf16 v[44:47], v[68:71], v[148:151], v[44:47]
  ds_read_b128 v[92:95], v15 offset:11264
  v_mul_f32 v113, v100, v113
  v_mfma_f32_16x16x32_bf16 v[40:43], v[68:71], v[144:147], v[40:43]
  s_waitcnt lgkmcnt(4)
L_bhf:
  s_cbranch_vccnz L_rhf
L_ohf:
  v_mfma_f32_16x16x32_bf16 v[32:35], v[72:75], v[152:155], v[32:35]
  ds_read_b128 v[64:67], v15 offset:12288
  v_fma_f32 v112, v112, v101, v101
  v_mfma_f32_16x16x32_bf16 v[36:39], v[72:75], v[156:159], v[36:39]
  v_exp_f32 v113, v113
  v_mfma_f32_16x16x32_bf16 v[44:47], v[76:79], v[156:159], v[44:47]
  ds_read_b128 v[68:71], v15 offset:13312
  v_mul_f32 v114, v100, v114
  v_mfma_f32_16x16x32_bf16 v[40:43], v[76:79], v[152:155], v[40:43]
  s_waitcnt lgkmcnt(4)
  buffer_load_dwordx4 v[128:131], v5, s[8:11], s40 offen offset:0 sc1
  v_mfma_f32_16x16x32_bf16 v[32:35], v[80:83], v[160:163], v[32:35]
  ds_read_b128 v[72:75], v15 offset:14336
  v_fma_f32 v113, v113, v101, v101
  v_mfma_f32_16x16x32_bf16 v[36:39], v[80:83], v[164:167], v[36:39]
  v_rcp_f32 v112, v112
  v_mfma_f32_16x16x32_bf16 v[44:47], v[84:87], v[164:167], v[44:47]
  ds_read_b128 v[76:79], v15 offset:15360
  v_mul_f32 v115, v100, v115
  v_mfma_f32_16x16x32_bf16 v[40:43], v[84:87], v[160:163], v[40:43]
  s_waitcnt lgkmcnt(4)
  buffer_load_dwordx4 v[132:135], v6, s[8:11], s40 offen offset:0 sc1
  v_mfma_f32_16x16x32_bf16 v[32:35], v[88:91], v[168:171], v[32:35]
  ds_read_b128 v[80:83], v15 offset:16384
  v_mul_f32 v112, v112, v120
  v_mfma_f32_16x16x32_bf16 v[36:39], v[88:91], v[172:175], v[36:39]
  v_exp_f32 v114, v114
  v_mfma_f32_16x16x32_bf16 v[44:47], v[92:95], v[172:175], v[44:47]
  ds_read_b128 v[84:87], v15 offset:17408
  v_fma_f32 v114, v114, v101, v101
  v_mfma_f32_16x16x32_bf16 v[40:43], v[92:95], v[168:171], v[40:43]
  s_waitcnt lgkmcnt(4)
  buffer_load_dwordx4 v[136:139], v7, s[8:11], s40 offen offset:0 sc1
  v_mfma_f32_16x16x32_bf16 v[32:35], v[64:67], v[176:179], v[32:35]
  ds_read_b128 v[88:91], v15 offset:18432
  v_mul_f32 v116, v102, v116
  v_mfma_f32_16x16x32_bf16 v[36:39], v[64:67], v[180:183], v[36:39]
  v_rcp_f32 v113, v113
  v_mfma_f32_16x16x32_bf16 v[44:47], v[68:71], v[180:183], v[44:47]
  ds_read_b128 v[92:95], v15 offset:19456
  v_mul_f32 v113, v113, v121
  v_mfma_f32_16x16x32_bf16 v[40:43], v[68:71], v[176:179], v[40:43]
  s_waitcnt lgkmcnt(4)
  buffer_load_dwordx4 v[140:143], v4, s[8:11], s40 offen offset:0 sc1
  v_mfma_f32_16x16x32_bf16 v[32:35], v[72:75], v[184:187], v[32:35]
  ds_read_b128 v[64:67], v15 offset:20480
  v_cvt_pk_bf16_f32 v96, v112, v113
  v_mfma_f32_16x16x32_bf16 v[36:39], v[72:75], v[188:191], v[36:39]
  v_exp_f32 v115, v115
  v_mfma_f32_16x16x32_bf16 v[44:47], v[76:79], v[188:191], v[44:47]
  ds_read_b128 v[68:71], v15 offset:21504
  v_fma_f32 v115, v115, v101, v101
  v_mfma_f32_16x16x32_bf16 v[40:43], v[76:79], v[184:187], v[40:43]
  s_waitcnt lgkmcnt(4)
  buffer_load_dwordx4 v[144:147], v5, s[8:11], s42 offen offset:0 sc1
  v_mfma_f32_16x16x32_bf16 v[32:35], v[80:83], v[192:195], v[32:35]
  ds_read_b128 v[72:75], v15 offset:22528
  v_mul_f32 v117, v102, v117
  v_mfma_f32_16x16x32_bf16 v[36:39], v[80:83], v[196:199], v[36:39]
  v_rcp_f32 v114, v114
  v_mfma_f32_16x16x32_bf16 v[44:47], v[84:87], v[196:199], v[44:47]
  ds_read_b128 v[76:79], v15 offset:23552
  v_mul_f32 v114, v114, v122
  v_mfma_f32_16x16x32_bf16 v[40:43], v[84:87], v[192:195], v[40:43]
  s_waitcnt lgkmcnt(4)
  buffer_load_dwordx4 v[148:151], v6, s[8:11], s42 offen offset:0 sc1
  v_mfma_f32_16x16x32_bf16 v[32:35], v[88:91], v[200:203], v[32:35]
  ds_read_b128 v[80:83], v15 offset:24576
  v_mul_f32 v118, v102, v118
  v_mfma_f32_16x16x32_bf16 v[36:39], v[88:91], v[204:207], v[36:39]
  v_exp_f32 v116, v116
  v_mfma_f32_16x16x32_bf16 v[44:47], v[92:95], v[204:207], v[44:47]
  ds_read_b128 v[84:87], v15 offset:25600
  v_fma_f32 v116, v116, v103, v103
  v_mfma_f32_16x16x32_bf16 v[40:43], v[92:95], v[200:203], v[40:43]
  s_waitcnt lgkmcnt(4)
  buffer_load_dwordx4 v[152:155], v7, s[8:11], s42 offen offset:0 sc1
  v_mfma_f32_16x16x32_bf16 v[32:35], v[64:67], v[208:211], v[32:35]
  ds_read_b128 v[88:91], v15 offset:26624
  v_mul_f32 v119, v102, v119
  v_mfma_f32_16x16x32_bf16 v[36:39], v[64:67], v[212:215], v[36:39]
  v_rcp_f32 v115, v115
  v_mfma_f32_16x16x32_bf16 v[44:47], v[68:71], v[212:215], v[44:47]
  ds_read_b128 v[92:95], v15 offset:27648
  v_mul_f32 v115, v115, v123
  v_mfma_f32_16x16x32_bf16 v[40:43], v[68:71], v[208:211], v[40:43]
  s_waitcnt lgkmcnt(4)
  buffer_load_dwordx4 v[156:159], v4, s[8:11], s42 offen offset:0 sc1
  v_mfma_f32_16x16x32_bf16 v[32:35], v[72:75], v[216:219], v[32:35]
  ds_read_b128 v[64:67], v15 offset:28672
  v_cvt_pk_bf16_f32 v97, v114, v115
  v_mfma_f32_16x16x32_bf16 v[36:39], v[72:75], v[220:223], v[36:39]
  v_exp_f32 v117, v117
  v_mfma_f32_16x16x32_bf16 v[44:47], v[76:79], v[220:223], v[44:47]
  ds_read_b128 v[68:71], v15 offset:29696
  v_fma_f32 v117, v117, v103, v103
  v_mfma_f32_16x16x32_bf16 v[40:43], v[76:79], v[216:219], v[40:43]
  s_waitcnt lgkmcnt(4)
  buffer_load_dwordx4 v[160:163], v5, s[8:11], s40 offen offset:1024 sc1
  v_mfma_f32_16x16x32_bf16 v[32:35], v[80:83], v[224:227], v[32:35]
  ds_read_b128 v[72:75], v15 offset:30720
  v_mfma_f32_16x16x32_bf16 v[36:39], v[80:83], v[228:231], v[36:39]
  v_rcp_f32 v116, v116
  v_mfma_f32_16x16x32_bf16 v[44:47], v[84:87], v[228:231], v[44:47]
  ds_read_b128 v[76:79], v15 offset:31744
  v_mul_f32 v116, v116, v124
  v_mfma_f32_16x16x32_bf16 v[40:43], v[84:87], v[224:227], v[40:43]
  s_waitcnt lgkmcnt(4)
  buffer_load_dwordx4 v[164:167], v6, s[8:11], s40 offen offset:1024 sc1
  v_mfma_f32_16x16x32_bf16 v[32:35], v[88:91], v[232:235], v[32:35]
  ds_read_b64 v[80:81], v16 offset:1536
  v_mfma_f32_16x16x32_bf16 v[36:39], v[88:91], v[236:239], v[36:39]
  v_exp_f32 v118, v118
  v_mfma_f32_16x16x32_bf16 v[44:47], v[92:95], v[236:239], v[44:47]
  ds_read_b64 v[84:85], v16 offset:1664
  v_fma_f32 v118, v118, v103, v103
  v_mfma_f32_16x16x32_bf16 v[40:43], v[92:95], v[232:235], v[40:43]
  s_waitcnt lgkmcnt(4)
  buffer_load_dwordx4 v[168:171], v7, s[8:11], s40 offen offset:1024 sc1
  v_mfma_f32_16x16x32_bf16 v[32:35], v[64:67], v[240:243], v[32:35]
  v_rcp_f32 v117, v117
  v_mfma_f32_16x16x32_bf16 v[36:39], v[64:67], v[244:247], v[36:39]
  v_exp_f32 v119, v119
  v_mfma_f32_16x16x32_bf16 v[44:47], v[68:71], v[244:247], v[44:47]
  v_rcp_f32 v118, v118
  v_mfma_f32_16x16x32_bf16 v[40:43], v[68:71], v[240:243], v[40:43]
  s_waitcnt lgkmcnt(2)
  buffer_load_dwordx4 v[172:175], v4, s[8:11], s40 offen offset:1024 sc1
  v_mfma_f32_16x16x32_bf16 v[32:35], v[72:75], v[248:251], v[32:35]
  v_mul_f32 v117, v117, v125
  v_fma_f32 v119, v119, v103, v103
  v_mfma_f32_16x16x32_bf16 v[36:39], v[72:75], v[252:255], v[36:39]
  v_rcp_f32 v119, v119
  v_mfma_f32_16x16x32_bf16 v[44:47], v[76:79], v[252:255], v[44:47]
  v_cvt_pk_bf16_f32 v98, v116, v117
  v_mul_f32 v118, v118, v126
  v_mfma_f32_16x16x32_bf16 v[40:43], v[76:79], v[248:251], v[40:43]
  s_waitcnt lgkmcnt(0)
  buffer_load_dwordx4 v[176:179], v5, s[8:11], s42 offen offset:1024 sc1
  v_mfma_f32_16x16x32_bf16 v[32:35], v[80:83], v[104:107], v[32:35]
  v_mul_f32 v119, v119, v127
  v_permlane16_swap_b32 v96, v98
  v_mfma_f32_16x16x32_bf16 v[36:39], v[80:83], v[108:111], v[36:39]
  v_cvt_pk_bf16_f32 v99, v118, v119
  v_mfma_f32_16x16x32_bf16 v[44:47], v[84:87], v[108:111], v[44:47]
  s_nop 0
  v_permlane16_swap_b32 v97, v99
  v_mfma_f32_16x16x32_bf16 v[40:43], v[84:87], v[104:107], v[40:43]
  buffer_store_dwordx4 v[96:99], v3, s[8:11], s45 offen offset:1024 sc1
  buffer_load_dwordx4 v[180:183], v6, s[8:11], s42 offen offset:1024 sc1
  buffer_load_dwordx4 v[184:187], v7, s[8:11], s42 offen offset:1024 sc1
  buffer_load_dwordx4 v[188:191], v4, s[8:11], s42 offen offset:1024 sc1
  buffer_load_dwordx4 v[192:195], v5, s[8:11], s40 offen offset:2048 sc1
  buffer_load_dwordx4 v[80:83], v25, s[8:11], s28 offen offset:0 sc1
  buffer_load_dwordx4 v[84:87], v25, s[8:11], s28 offen offset:16 sc1
  v_pk_mul_f32 v[32:33], v[32:33], v[100:101] op_sel_hi:[1,0]
  v_pk_mul_f32 v[34:35], v[34:35], v[100:101] op_sel_hi:[1,0]
  v_pk_mul_f32 v[36:37], v[36:37], v[102:103] op_sel_hi:[1,0]
  v_pk_mul_f32 v[38:39], v[38:39], v[102:103] op_sel_hi:[1,0]
  v_exp_f32 v32, v32
  v_exp_f32 v33, v33
  v_exp_f32 v34, v34
  v_exp_f32 v35, v35
  v_exp_f32 v36, v36
  v_exp_f32 v37, v37
  v_exp_f32 v38, v38
  v_exp_f32 v39, v39
  v_pk_fma_f32 v[32:33], v[32:33], v[100:101], v[100:101] op_sel:[0,1,1] op_sel_hi:[1,1,1]
  v_pk_fma_f32 v[34:35], v[34:35], v[100:101], v[100:101] op_sel:[0,1,1] op_sel_hi:[1,1,1]
  v_pk_fma_f32 v[36:37], v[36:37], v[102:103], v[102:103] op_sel:[0,1,1] op_sel_hi:[1,1,1]
  v_pk_fma_f32 v[38:39], v[38:39], v[102:103], v[102:103] op_sel:[0,1,1] op_sel_hi:[1,1,1]
  v_rcp_f32 v32, v32
  v_rcp_f32 v33, v33
  v_rcp_f32 v34, v34
  v_rcp_f32 v35, v35
  v_rcp_f32 v36, v36
  v_rcp_f32 v37, v37
  v_rcp_f32 v38, v38
  v_rcp_f32 v39, v39
  v_pk_mul_f32 v[32:33], v[32:33], v[40:41]
  v_pk_mul_f32 v[34:35], v[34:35], v[42:43]
  v_pk_mul_f32 v[36:37], v[36:37], v[44:45]
  v_pk_mul_f32 v[38:39], v[38:39], v[46:47]
  v_cvt_pk_bf16_f32 v96, v32, v33
  v_cvt_pk_bf16_f32 v98, v36, v37
  v_cvt_pk_bf16_f32 v97, v34, v35
  v_cvt_pk_bf16_f32 v99, v38, v39
  v_permlane16_swap_b32 v96, v98
  s_nop 0
  v_permlane16_swap_b32 v97, v99
  buffer_store_dwordx4 v[96:99], v3, s[8:11], s45 offen offset:2048 sc1
  s_waitcnt vmcnt(17)
  v_mfma_f32_16x16x32_bf16 v[64:67], v[128:131], a[0:3], 0
  buffer_load_dwordx4 v[196:199], v6, s[8:11], s40 offen offset:2048 sc1
  v_mfma_f32_16x16x32_bf16 v[68:71], v[128:131], a[4:7], 0
  v_mfma_f32_16x16x32_bf16 v[72:75], v[128:131], a[8:11], 0
  v_mfma_f32_16x16x32_bf16 v[76:79], v[128:131], a[12:15], 0
  v_mfma_f32_16x16x32_bf16 a[224:227], v[132:135], a[0:3], 0
  buffer_load_dwordx4 v[200:203], v7, s[8:11], s40 offen offset:2048 sc1
  v_mfma_f32_16x16x32_bf16 a[228:231], v[132:135], a[4:7], 0
  v_mfma_f32_16x16x32_bf16 a[232:235], v[132:135], a[8:11], 0
  v_mfma_f32_16x16x32_bf16 a[236:239], v[132:135], a[12:15], 0
  v_mfma_f32_16x16x32_bf16 a[240:243], v[136:139], a[0:3], 0
  buffer_load_dwordx4 v[204:207], v4, s[8:11], s40 offen offset:2048 sc1
  v_mfma_f32_16x16x32_bf16 a[244:247], v[136:139], a[4:7], 0
  v_mfma_f32_16x16x32_bf16 a[248:251], v[136:139], a[8:11], 0
  v_mfma_f32_16x16x32_bf16 a[252:255], v[136:139], a[12:15], 0
  v_mfma_f32_16x16x32_bf16 v[48:51], v[140:143], a[0:3], 0
  buffer_load_dwordx4 v[208:211], v5, s[8:11], s42 offen offset:2048 sc1
  v_mfma_f32_16x16x32_bf16 v[52:55], v[140:143], a[4:7], 0
  v_mfma_f32_16x16x32_bf16 v[56:59], v[140:143], a[8:11], 0
  v_mfma_f32_16x16x32_bf16 v[60:63], v[140:143], a[12:15], 0
  s_waitcnt vmcnt(17)
  v_mfma_f32_16x16x32_bf16 v[64:67], v[144:147], a[16:19], v[64:67]
  buffer_load_dwordx4 v[212:215], v6, s[8:11], s42 offen offset:2048 sc1
  v_mfma_f32_16x16x32_bf16 v[68:71], v[144:147], a[20:23], v[68:71]
  v_mfma_f32_16x16x32_bf16 v[72:75], v[144:147], a[24:27], v[72:75]
  v_mfma_f32_16x16x32_bf16 v[76:79], v[144:147], a[28:31], v[76:79]
  v_mfma_f32_16x16x32_bf16 a[224:227], v[148:151], a[16:19], a[224:227]
  buffer_load_dwordx4 v[216:219], v7, s[8:11], s42 offen offset:2048 sc1
  v_mfma_f32_16x16x32_bf16 a[228:231], v[148:151], a[20:23], a[228:231]
  v_mfma_f32_16x16x32_bf16 a[232:235], v[148:151], a[24:27], a[232:235]
  v_mfma_f32_16x16x32_bf16 a[236:239], v[148:151], a[28:31], a[236:239]
  v_mfma_f32_16x16x32_bf16 a[240:243], v[152:155], a[16:19], a[240:243]
  buffer_load_dwordx4 v[220:223], v4, s[8:11], s42 offen offset:2048 sc1
  v_mfma_f32_16x16x32_bf16 a[244:247], v[152:155], a[20:23], a[244:247]
  v_mfma_f32_16x16x32_bf16 a[248:251], v[152:155], a[24:27], a[248:251]
  v_mfma_f32_16x16x32_bf16 a[252:255], v[152:155], a[28:31], a[252:255]
  v_mfma_f32_16x16x32_bf16 v[48:51], v[156:159], a[16:19], v[48:51]
  buffer_load_dwordx4 v[224:227], v5, s[8:11], s40 offen offset:3072 sc1
  v_mfma_f32_16x16x32_bf16 v[52:55], v[156:159], a[20:23], v[52:55]
  v_mfma_f32_16x16x32_bf16 v[56:59], v[156:159], a[24:27], v[56:59]
  v_mfma_f32_16x16x32_bf16 v[60:63], v[156:159], a[28:31], v[60:63]
  s_waitcnt vmcnt(17)
  v_mfma_f32_16x16x32_bf16 v[64:67], v[160:163], a[32:35], v[64:67]
  buffer_load_dwordx4 v[228:231], v6, s[8:11], s40 offen offset:3072 sc1
  v_mfma_f32_16x16x32_bf16 v[68:71], v[160:163], a[36:39], v[68:71]
  v_mfma_f32_16x16x32_bf16 v[72:75], v[160:163], a[40:43], v[72:75]
  s_add_u32 m0, s18, 133120
  s_nop 0
  buffer_load_dwordx4 v24, s[8:11], s27 offen sc1 lds
  v_mfma_f32_16x16x32_bf16 v[76:79], v[160:163], a[44:47], v[76:79]
  v_mfma_f32_16x16x32_bf16 a[224:227], v[164:167], a[32:35], a[224:227]
  buffer_load_dwordx4 v[232:235], v7, s[8:11], s40 offen offset:3072 sc1
  v_mfma_f32_16x16x32_bf16 a[228:231], v[164:167], a[36:39], a[228:231]
  v_mfma_f32_16x16x32_bf16 a[232:235], v[164:167], a[40:43], a[232:235]
  v_mfma_f32_16x16x32_bf16 a[236:239], v[164:167], a[44:47], a[236:239]
  v_mfma_f32_16x16x32_bf16 a[240:243], v[168:171], a[32:35], a[240:243]
  buffer_load_dwordx4 v[236:239], v4, s[8:11], s40 offen offset:3072 sc1
  v_mfma_f32_16x16x32_bf16 a[244:247], v[168:171], a[36:39], a[244:247]
  v_mfma_f32_16x16x32_bf16 a[248:251], v[168:171], a[40:43], a[248:251]
  v_mfma_f32_16x16x32_bf16 a[252:255], v[168:171], a[44:47], a[252:255]
  v_mfma_f32_16x16x32_bf16 v[48:51], v[172:175], a[32:35], v[48:51]
  buffer_load_dwordx4 v[240:243], v5, s[8:11], s42 offen offset:3072 sc1
  v_mfma_f32_16x16x32_bf16 v[52:55], v[172:175], a[36:39], v[52:55]
  v_mfma_f32_16x16x32_bf16 v[56:59], v[172:175], a[40:43], v[56:59]
  v_mfma_f32_16x16x32_bf16 v[60:63], v[172:175], a[44:47], v[60:63]
  s_waitcnt vmcnt(17)
  v_mfma_f32_16x16x32_bf16 v[64:67], v[176:179], a[48:51], v[64:67]
  buffer_load_dwordx4 v[244:247], v6, s[8:11], s42 offen offset:3072 sc1
  v_mfma_f32_16x16x32_bf16 v[68:71], v[176:179], a[52:55], v[68:71]
  v_mfma_f32_16x16x32_bf16 v[72:75], v[176:179], a[56:59], v[72:75]
  buffer_load_dwordx4 v24, s[8:11], s23 offen offset:1024 sc1 lds
  v_mfma_f32_16x16x32_bf16 v[76:79], v[176:179], a[60:63], v[76:79]
  v_mfma_f32_16x16x32_bf16 a[224:227], v[180:183], a[48:51], a[224:227]
  buffer_load_dwordx4 v[248:251], v7, s[8:11], s42 offen offset:3072 sc1
  v_mfma_f32_16x16x32_bf16 a[228:231], v[180:183], a[52:55], a[228:231]
  s_waitcnt vmcnt(13)
  v_max3_u32 v30, v192, v193, v194
  v_max3_u32 v30, v30, v195, v196
  v_mfma_f32_16x16x32_bf16 a[232:235], v[180:183], a[56:59], a[232:235]
  v_mfma_f32_16x16x32_bf16 a[236:239], v[180:183], a[60:63], a[236:239]
  v_max3_u32 v30, v30, v197, v198
  v_max3_u32 v30, v30, v199, v200
  v_mfma_f32_16x16x32_bf16 a[240:243], v[184:187], a[48:51], a[240:243]
  buffer_load_dwordx4 v[252:255], v5, s[8:11], s41 offen offset:0 sc1
  v_mfma_f32_16x16x32_bf16 a[244:247], v[184:187], a[52:55], a[244:247]
  v_max3_u32 v30, v30, v201, v202
  v_max3_u32 v30, v30, v203, v204
  v_mfma_f32_16x16x32_bf16 a[248:251], v[184:187], a[56:59], a[248:251]
  v_mfma_f32_16x16x32_bf16 a[252:255], v[184:187], a[60:63], a[252:255]
  v_max3_u32 v30, v30, v205, v206
  v_max_u32 v30, v30, v207
  v_mfma_f32_16x16x32_bf16 v[48:51], v[188:191], a[48:51], v[48:51]
  buffer_load_dwordx4 v[128:131], v6, s[8:11], s41 offen offset:0 sc1
  v_mfma_f32_16x16x32_bf16 v[52:55], v[188:191], a[52:55], v[52:55]
  v_cmp_eq_u32 vcc, -1, v30
  v_mfma_f32_16x16x32_bf16 v[56:59], v[188:191], a[56:59], v[56:59]
  v_mfma_f32_16x16x32_bf16 v[60:63], v[188:191], a[60:63], v[60:63]
L_hb4:
  s_cbranch_vccnz L_hr4
L_ho4:
  v_mfma_f32_16x16x32_bf16 v[64:67], v[192:195], a[64:67], v[64:67]
  buffer_load_dwordx4 v[132:135], v7, s[8:11], s41 offen offset:0 sc1
  v_mfma_f32_16x16x32_bf16 v[68:71], v[192:195], a[68:71], v[68:71]
  v_mfma_f32_16x16x32_bf16 v[72:75], v[192:195], a[72:75], v[72:75]
  v_mfma_f32_16x16x32_bf16 v[76:79], v[192:195], a[76:79], v[76:79]
  v_mfma_f32_16x16x32_bf16 a[224:227], v[196:199], a[64:67], a[224:227]
  buffer_load_dwordx4 v[136:139], v5, s[8:11], s43 offen offset:0 sc1
  v_mfma_f32_16x16x32_bf16 a[228:231], v[196:199], a[68:71], a[228:231]
  s_waitcnt vmcnt(13)
  v_max3_u32 v30, v208, v209, v210
  v_max3_u32 v30, v30, v211, v212
  v_mfma_f32_16x16x32_bf16 a[232:235], v[196:199], a[72:75], a[232:235]
  v_mfma_f32_16x16x32_bf16 a[236:239], v[196:199], a[76:79], a[236:239]
  v_max3_u32 v30, v30, v213, v214
  v_max3_u32 v30, v30, v215, v216
  v_mfma_f32_16x16x32_bf16 a[240:243], v[200:203], a[64:67], a[240:243]
  buffer_load_dwordx4 v[140:143], v6, s[8:11], s43 offen offset:0 sc1
  v_mfma_f32_16x16x32_bf16 a[244:247], v[200:203], a[68:71], a[244:247]
  v_max3_u32 v30, v30, v217, v218
  v_max3_u32 v30, v30, v219, v220
  v_mfma_f32_16x16x32_bf16 a[248:251], v[200:203], a[72:75], a[248:251]
  v_mfma_f32_16x16x32_bf16 a[252:255], v[200:203], a[76:79], a[252:255]
  v_max3_u32 v30, v30, v221, v222
  v_max_u32 v30, v30, v223
  v_mfma_f32_16x16x32_bf16 v[48:51], v[204:207], a[64:67], v[48:51]
  buffer_load_dwordx4 v[144:147], v7, s[8:11], s43 offen offset:0 sc1
  v_mfma_f32_16x16x32_bf16 v[52:55], v[204:207], a[68:71], v[52:55]
  v_cmp_eq_u32 vcc, -1, v30
  v_mfma_f32_16x16x32_bf16 v[56:59], v[204:207], a[72:75], v[56:59]
  v_mfma_f32_16x16x32_bf16 v[60:63], v[204:207], a[76:79], v[60:63]
L_hb5:
  s_cbranch_vccnz L_hr5
L_ho5:
  v_mfma_f32_16x16x32_bf16 v[64:67], v[208:211], a[80:83], v[64:67]
  buffer_load_dwordx4 v[148:151], v5, s[8:11], s41 offen offset:1024 sc1
  v_mfma_f32_16x16x32_bf16 v[68:71], v[208:211], a[84:87], v[68:71]
  v_mfma_f32_16x16x32_bf16 v[72:75], v[208:211], a[88:91], v[72:75]
  v_mfma_f32_16x16x32_bf16 v[76:79], v[208:211], a[92:95], v[76:79]
  v_mfma_f32_16x16x32_bf16 a[224:227], v[212:215], a[80:83], a[224:227]
  buffer_load_dwordx4 v[152:155], v6, s[8:11], s41 offen offset:1024 sc1
  v_mfma_f32_16x16x32_bf16 a[228:231], v[212:215], a[84:87], a[228:231]
  s_waitcnt vmcnt(12)
  v_max3_u32 v30, v224, v225, v226
  v_max3_u32 v30, v30, v227, v228
  v_mfma_f32_16x16x32_bf16 a[232:235], v[212:215], a[88:91], a[232:235]
  v_mfma_f32_16x16x32_bf16 a[236:239], v[212:215], a[92:95], a[236:239]
  v_max3_u32 v30, v30, v229, v230
  v_max3_u32 v30, v30, v231, v232
  v_mfma_f32_16x16x32_bf16 a[240:243], v[216:219], a[80:83], a[240:243]
  buffer_load_dwordx4 v[156:159], v7, s[8:11], s41 offen offset:1024 sc1
  v_mfma_f32_16x16x32_bf16 a[244:247], v[216:219], a[84:87], a[244:247]
  v_max3_u32 v30, v30, v233, v234
  v_max3_u32 v30, v30, v235, v236
  v_mfma_f32_16x16x32_bf16 a[248:251], v[216:219], a[88:91], a[248:251]
  v_mfma_f32_16x16x32_bf16 a[252:255], v[216:219], a[92:95], a[252:255]
  v_max3_u32 v30, v30, v237, v238
  v_max_u32 v30, v30, v239
  v_mfma_f32_16x16x32_bf16 v[48:51], v[220:223], a[80:83], v[48:51]
  buffer_load_dwordx4 v[160:163], v5, s[8:11], s43 offen offset:1024 sc1
  v_mfma_f32_16x16x32_bf16 v[52:55], v[220:223], a[84:87], v[52:55]
  v_cmp_eq_u32 vcc, -1, v30
  v_mfma_f32_16x16x32_bf16 v[56:59], v[220:223], a[88:91], v[56:59]
  v_mfma_f32_16x16x32_bf16 v[60:63], v[220:223], a[92:95], v[60:63]
L_hb6:
  s_cbranch_vccnz L_hr6
L_ho6:
  v_mfma_f32_16x16x32_bf16 v[64:67], v[224:227], a[96:99], v[64:67]
  buffer_load_dwordx4 v[164:167], v6, s[8:11], s43 offen offset:1024 sc1
  v_mfma_f32_16x16x32_bf16 v[68:71], v[224:227], a[100:103], v[68:71]
  v_permlane32_swap_b32 v80, v84
  v_mfma_f32_16x16x32_bf16 v[72:75], v[224:227], a[104:107], v[72:75]
  v_permlane32_swap_b32 v82, v86
  v_mfma_f32_16x16x32_bf16 v[76:79], v[224:227], a[108:111], v[76:79]
  v_add_f32 v80, v80, v84
  v_mfma_f32_16x16x32_bf16 a[224:227], v[228:231], a[96:99], a[224:227]
  buffer_load_dwordx4 v[168:171], v7, s[8:11], s43 offen offset:1024 sc1
  v_mfma_f32_16x16x32_bf16 a[228:231], v[228:231], a[100:103], a[228:231]
  s_waitcnt vmcnt(11)
  v_max3_u32 v30, v240, v241, v242
  v_max3_u32 v30, v30, v243, v244
  v_mfma_f32_16x16x32_bf16 a[232:235], v[228:231], a[104:107], a[232:235]
  ds_read_b64 v[120:121], v0 offset:0
  v_mfma_f32_16x16x32_bf16 a[236:239], v[228:231], a[108:111], a[236:239]
  v_max3_u32 v30, v30, v245, v246
  v_max3_u32 v30, v30, v247, v248
  v_mfma_f32_16x16x32_bf16 a[240:243], v[232:235], a[96:99], a[240:243]
  buffer_load_dwordx4 v[172:175], v5, s[8:11], s41 offen offset:2048 sc1
  v_mfma_f32_16x16x32_bf16 a[244:247], v[232:235], a[100:103], a[244:247]
  v_max3_u32 v30, v30, v249, v250
  v_max3_u32 v30, v30, v251, v252
  v_mfma_f32_16x16x32_bf16 a[248:251], v[232:235], a[104:107], a[248:251]
  ds_read_b64 v[122:123], v0 offset:32
  v_mfma_f32_16x16x32_bf16 a[252:255], v[232:235], a[108:111], a[252:255]
  v_max3_u32 v30, v30, v253, v254
  v_max_u32 v30, v30, v255
  v_mfma_f32_16x16x32_bf16 v[48:51], v[236:239], a[96:99], v[48:51]
  buffer_load_dwordx4 v[176:179], v5, s[8:11], s43 offen offset:2048 sc1
  v_mfma_f32_16x16x32_bf16 v[52:55], v[236:239], a[100:103], v[52:55]
  v_cmp_eq_u32 vcc, -1, v30
  v_mfma_f32_16x16x32_bf16 v[56:59], v[236:239], a[104:107], v[56:59]
  ds_read_b64 v[124:125], v0 offset:64
  v_mfma_f32_16x16x32_bf16 v[60:63], v[236:239], a[108:111], v[60:63]
  ds_read_b64 v[126:127], v0 offset:96
L_hb7:
  s_cbranch_vccnz L_hr7
L_ho7:
  v_mfma_f32_16x16x32_bf16 v[64:67], v[240:243], a[112:115], v[64:67]
  buffer_load_dwordx4 v[180:183], v6, s[8:11], s41 offen offset:2048 sc1
  v_mfma_f32_16x16x32_bf16 v[68:71], v[240:243], a[116:119], v[68:71]
  v_add_f32 v82, v82, v86
  v_mfma_f32_16x16x32_bf16 v[72:75], v[240:243], a[120:123], v[72:75]
  v_mov_b32 v81, v80
  v_mfma_f32_16x16x32_bf16 v[76:79], v[240:243], a[124:127], v[76:79]
  v_mov_b32 v83, v82
  v_mfma_f32_16x16x32_bf16 a[224:227], v[244:247], a[112:115], a[224:227]
  buffer_load_dwordx4 v[184:187], v6, s[8:11], s43 offen offset:2048 sc1
  v_mfma_f32_16x16x32_bf16 a[228:231], v[244:247], a[116:119], a[228:231]
  s_waitcnt vmcnt(11)
  v_max3_u32 v30, v128, v129, v130
  v_max3_u32 v30, v30, v131, v132
  v_mfma_f32_16x16x32_bf16 a[232:235], v[244:247], a[120:123], a[232:235]
  v_permlane16_swap_b32 v80, v81
  v_mfma_f32_16x16x32_bf16 a[236:239], v[244:247], a[124:127], a[236:239]
  v_max3_u32 v30, v30, v133, v134
  v_max3_u32 v30, v30, v135, v136
  v_mfma_f32_16x16x32_bf16 a[240:243], v[248:251], a[112:115], a[240:243]
  buffer_load_dwordx4 v[188:191], v7, s[8:11], s41 offen offset:2048 sc1
  v_mfma_f32_16x16x32_bf16 a[244:247], v[248:251], a[116:119], a[244:247]
  v_max3_u32 v30, v30, v137, v138
  v_max3_u32 v30, v30, v139, v140
  v_mfma_f32_16x16x32_bf16 a[248:251], v[248:251], a[120:123], a[248:251]
  v_permlane16_swap_b32 v82, v83
  v_mfma_f32_16x16x32_bf16 a[252:255], v[248:251], a[124:127], a[252:255]
  v_max3_u32 v30, v30, v141, v142
  v_max_u32 v30, v30, v143
  v_mfma_f32_16x16x32_bf16 v[64:67], v[252:255], a[128:131], v[64:67]
  buffer_load_dwordx4 v[192:195], v7, s[8:11], s43 offen offset:2048 sc1
  v_mfma_f32_16x16x32_bf16 v[68:71], v[252:255], a[132:135], v[68:71]
  v_cmp_eq_u32 vcc, -1, v30
  v_mfma_f32_16x16x32_bf16 v[72:75], v[252:255], a[136:139], v[72:75]
  v_add_f32 v80, v80, v81
  v_mfma_f32_16x16x32_bf16 v[76:79], v[252:255], a[140:143], v[76:79]
  v_add_f32 v82, v82, v83
L_hb8:
  s_cbranch_vccnz L_hr8
L_ho8:
  v_mfma_f32_16x16x32_bf16 a[224:227], v[128:131], a[128:131], a[224:227]
  buffer_load_dwordx4 v[196:199], v4, s[8:11], s42 offen offset:3072 sc1
  v_mfma_f32_16x16x32_bf16 a[228:231], v[128:131], a[132:135], a[228:231]
  v_cvt_pk_bf16_f32 v80, v80, v82
  v_mfma_f32_16x16x32_bf16 a[232:235], v[128:131], a[136:139], a[232:235]
  v_mov_b32 v84, v80
  v_mfma_f32_16x16x32_bf16 a[236:239], v[128:131], a[140:143], a[236:239]
  s_nop 0
  v_permlane32_swap_b32 v80, v84
  v_mfma_f32_16x16x32_bf16 a[240:243], v[132:135], a[128:131], a[240:243]
  buffer_load_dwordx4 v[200:203], v4, s[8:11], s41 offen offset:0 sc1
  v_mfma_f32_16x16x32_bf16 a[244:247], v[132:135], a[132:135], a[244:247]
  s_waitcnt vmcnt(11)
  v_max3_u32 v30, v144, v145, v146
  v_max3_u32 v30, v30, v147, v148
  v_mfma_f32_16x16x32_bf16 a[248:251], v[132:135], a[136:139], a[248:251]
  v_and_b32 v82, 0xffff0000, v80
  v_mfma_f32_16x16x32_bf16 a[252:255], v[132:135], a[140:143], a[252:255]
  v_max3_u32 v30, v30, v149, v150
  v_max3_u32 v30, v30, v151, v152
  v_mfma_f32_16x16x32_bf16 v[64:67], v[136:139], a[144:147], v[64:67]
  buffer_load_dwordx4 v[204:207], v4, s[8:11], s43 offen offset:0 sc1
  v_mfma_f32_16x16x32_bf16 v[68:71], v[136:139], a[148:151], v[68:71]
  v_max3_u32 v30, v30, v153, v154
  v_max3_u32 v30, v30, v155, v156
  v_mfma_f32_16x16x32_bf16 v[72:75], v[136:139], a[152:155], v[72:75]
  v_and_b32 v86, 0xffff0000, v84
  v_mfma_f32_16x16x32_bf16 v[76:79], v[136:139], a[156:159], v[76:79]
  v_max3_u32 v30, v30, v157, v158
  v_max_u32 v30, v30, v159
  v_mfma_f32_16x16x32_bf16 a[224:227], v[140:143], a[144:147], a[224:227]
  buffer_load_dwordx4 v[208:211], v4, s[8:11], s41 offen offset:1024 sc1
  v_mfma_f32_16x16x32_bf16 a[228:231], v[140:143], a[148:151], a[228:231]
  v_cmp_eq_u32 vcc, -1, v30
  v_mfma_f32_16x16x32_bf16 a[232:235], v[140:143], a[152:155], a[232:235]
  v_lshlrev_b32 v80, 16, v80
  v_mfma_f32_16x16x32_bf16 a[236:239], v[140:143], a[156:159], a[236:239]
  v_lshlrev_b32 v84, 16, v84
L_hb9:
  s_cbranch_vccnz L_hr9
L_ho9:
  v_mfma_f32_16x16x32_bf16 a[240:243], v[144:147], a[144:147], a[240:243]
  buffer_load_dwordx4 v[212:215], v4, s[8:11], s43 offen offset:1024 sc1
  v_mfma_f32_16x16x32_bf16 a[244:247], v[144:147], a[148:151], a[244:247]
  s_waitcnt lgkmcnt(0)
  v_lshlrev_b32 v32, 16, v120
  v_and_b32 v33, 0xffff0000, v120
  v_mfma_f32_16x16x32_bf16 a[248:251], v[144:147], a[152:155], a[248:251]
  v_lshlrev_b32 v34, 16, v121
  v_and_b32 v35, 0xffff0000, v121
  v_mfma_f32_16x16x32_bf16 a[252:255], v[144:147], a[156:159], a[252:255]
  v_lshlrev_b32 v36, 16, v122
  v_and_b32 v37, 0xffff0000, v122
  v_mfma_f32_16x16x32_bf16 v[64:67], v[148:151], a[160:163], v[64:67]
  buffer_load_dwordx4 v[216:219], v4, s[8:11], s41 offen offset:2048 sc1
  v_mfma_f32_16x16x32_bf16 v[68:71], v[148:151], a[164:167], v[68:71]
  s_waitcnt vmcnt(11)
  v_max3_u32 v30, v160, v161, v162
  v_max3_u32 v30, v30, v163, v164
  v_mfma_f32_16x16x32_bf16 v[72:75], v[148:151], a[168:171], v[72:75]
  v_lshlrev_b32 v38, 16, v123
  v_and_b32 v39, 0xffff0000, v123
  v_mfma_f32_16x16x32_bf16 v[76:79], v[148:151], a[172:175], v[76:79]
  v_max3_u32 v30, v30, v165, v166
  v_max3_u32 v30, v30, v167, v168
  v_mfma_f32_16x16x32_bf16 a[224:227], v[152:155], a[160:163], a[224:227]
  buffer_load_dwordx4 v[220:223], v4, s[8:11], s43 offen offset:2048 sc1
  v_mfma_f32_16x16x32_bf16 a[228:231], v[152:155], a[164:167], a[228:231]
  v_max3_u32 v30, v30, v169, v170
  v_max3_u32 v30, v30, v171, v172
  v_mfma_f32_16x16x32_bf16 a[232:235], v[152:155], a[168:171], a[232:235]
  v_lshlrev_b32 v40, 16, v124
  v_and_b32 v41, 0xffff0000, v124
  v_mfma_f32_16x16x32_bf16 a[236:239], v[152:155], a[172:175], a[236:239]
  v_max3_u32 v30, v30, v173, v174
  v_max_u32 v30, v30, v175
  v_mfma_f32_16x16x32_bf16 a[240:243], v[156:159], a[160:163], a[240:243]
  v_lshlrev_b32 v42, 16, v125
  v_and_b32 v43, 0xffff0000, v125
  v_mfma_f32_16x16x32_bf16 a[244:247], v[156:159], a[164:167], a[244:247]
  v_cmp_eq_u32 vcc, -1, v30
  v_mfma_f32_16x16x32_bf16 a[248:251], v[156:159], a[168:171], a[248:251]
  v_lshlrev_b32 v44, 16, v126
  v_and_b32 v45, 0xffff0000, v126
  v_mfma_f32_16x16x32_bf16 a[252:255], v[156:159], a[172:175], a[252:255]
  v_lshlrev_b32 v46, 16, v127
  v_and_b32 v47, 0xffff0000, v127
L_hb10:
  s_cbranch_vccnz L_hr10
L_ho10:
  v_mfma_f32_16x16x32_bf16 v[64:67], v[160:163], a[176:179], v[64:67]
  v_mfma_f32_16x16x32_bf16 v[68:71], v[160:163], a[180:183], v[68:71]
  v_mfma_f32_16x16x32_bf16 v[72:75], v[160:163], a[184:187], v[72:75]
  v_mfma_f32_16x16x32_bf16 v[76:79], v[160:163], a[188:191], v[76:79]
  v_mfma_f32_16x16x32_bf16 a[224:227], v[164:167], a[176:179], a[224:227]
  v_mfma_f32_16x16x32_bf16 a[228:231], v[164:167], a[180:183], a[228:231]
  s_waitcnt vmcnt(8)
  v_max3_u32 v30, v176, v177, v178
  v_max3_u32 v30, v30, v179, v180
  v_mfma_f32_16x16x32_bf16 a[232:235], v[164:167], a[184:187], a[232:235]
  v_mfma_f32_16x16x32_bf16 a[236:239], v[164:167], a[188:191], a[236:239]
  v_max3_u32 v30, v30, v181, v182
  v_max3_u32 v30, v30, v183, v184
  v_mfma_f32_16x16x32_bf16 a[240:243], v[168:171], a[176:179], a[240:243]
  v_mfma_f32_16x16x32_bf16 a[244:247], v[168:171], a[180:183], a[244:247]
  v_max3_u32 v30, v30, v185, v186
  v_max3_u32 v30, v30, v187, v188
  v_mfma_f32_16x16x32_bf16 a[248:251], v[168:171], a[184:187], a[248:251]
  v_mfma_f32_16x16x32_bf16 a[252:255], v[168:171], a[188:191], a[252:255]
  v_max3_u32 v30, v30, v189, v190
  v_max_u32 v30, v30, v191
  v_mfma_f32_16x16x32_bf16 v[64:67], v[172:175], a[192:195], v[64:67]
  v_mfma_f32_16x16x32_bf16 v[68:71], v[172:175], a[196:199], v[68:71]
  v_cmp_eq_u32 vcc, -1, v30
  v_mfma_f32_16x16x32_bf16 v[72:75], v[172:175], a[200:203], v[72:75]
  v_mfma_f32_16x16x32_bf16 v[76:79], v[172:175], a[204:207], v[76:79]
L_hb11:
  s_cbranch_vccnz L_hr11
L_ho11:
  v_mfma_f32_16x16x32_bf16 v[64:67], v[176:179], a[208:211], v[64:67]
  v_mfma_f32_16x16x32_bf16 v[68:71], v[176:179], a[212:215], v[68:71]
  v_mfma_f32_16x16x32_bf16 v[72:75], v[176:179], a[216:219], v[72:75]
  v_mfma_f32_16x16x32_bf16 v[76:79], v[176:179], a[220:223], v[76:79]
  v_mfma_f32_16x16x32_bf16 a[224:227], v[180:183], a[192:195], a[224:227]
  v_mfma_f32_16x16x32_bf16 a[228:231], v[180:183], a[196:199], a[228:231]
  s_waitcnt vmcnt(4)
  v_max3_u32 v30, v192, v193, v194
  v_max3_u32 v30, v30, v195, v196
  v_mfma_f32_16x16x32_bf16 a[232:235], v[180:183], a[200:203], a[232:235]
  ds_write_b128 v17, v[64:67] offset:0
  v_mfma_f32_16x16x32_bf16 a[236:239], v[180:183], a[204:207], a[236:239]
  v_max3_u32 v30, v30, v197, v198
  v_max3_u32 v30, v30, v199, v200
  v_mfma_f32_16x16x32_bf16 a[224:227], v[184:187], a[208:211], a[224:227]
  ds_write_b128 v17, v[68:71] offset:1024
  v_mfma_f32_16x16x32_bf16 a[228:231], v[184:187], a[212:215], a[228:231]
  v_max3_u32 v30, v30, v201, v202
  v_max3_u32 v30, v30, v203, v204
  v_mfma_f32_16x16x32_bf16 a[232:235], v[184:187], a[216:219], a[232:235]
  ds_write_b128 v17, v[72:75] offset:2048
  v_mfma_f32_16x16x32_bf16 a[236:239], v[184:187], a[220:223], a[236:239]
  v_max3_u32 v30, v30, v205, v206
  v_max_u32 v30, v30, v207
  v_mfma_f32_16x16x32_bf16 a[240:243], v[188:191], a[192:195], a[240:243]
  ds_write_b128 v17, v[76:79] offset:3072
  v_mfma_f32_16x16x32_bf16 a[244:247], v[188:191], a[196:199], a[244:247]
  v_cmp_eq_u32 vcc, -1, v30
  v_mfma_f32_16x16x32_bf16 a[248:251], v[188:191], a[200:203], a[248:251]
  ds_write_b128 v18, a[224:227] offset:0
  v_mfma_f32_16x16x32_bf16 a[252:255], v[188:191], a[204:207], a[252:255]
L_hb12:
  s_cbranch_vccnz L_hr12
L_ho12:
  v_mfma_f32_16x16x32_bf16 a[240:243], v[192:195], a[208:211], a[240:243]
  ds_write_b128 v18, a[228:231] offset:1024
  v_mfma_f32_16x16x32_bf16 a[244:247], v[192:195], a[212:215], a[244:247]
  v_mfma_f32_16x16x32_bf16 a[248:251], v[192:195], a[216:219], a[248:251]
  ds_write_b128 v18, a[232:235] offset:2048
  v_mfma_f32_16x16x32_bf16 a[252:255], v[192:195], a[220:223], a[252:255]
  v_mfma_f32_16x16x32_bf16 v[48:51], v[196:199], a[112:115], v[48:51]
  ds_write_b128 v18, a[236:239] offset:3072
  v_mfma_f32_16x16x32_bf16 v[52:55], v[196:199], a[116:119], v[52:55]
  s_waitcnt vmcnt(0)
  v_max3_u32 v30, v208, v209, v210
  v_max3_u32 v30, v30, v211, v212
  v_mfma_f32_16x16x32_bf16 v[56:59], v[196:199], a[120:123], v[56:59]
  ds_write_b128 v20, a[240:243] offset:0
  v_mfma_f32_16x16x32_bf16 v[60:63], v[196:199], a[124:127], v[60:63]
  v_max3_u32 v30, v30, v213, v214
  v_max3_u32 v30, v30, v215, v216
  v_mfma_f32_16x16x32_bf16 v[48:51], v[200:203], a[128:131], v[48:51]
  ds_write_b128 v20, a[244:247] offset:1024
  v_mfma_f32_16x16x32_bf16 v[52:55], v[200:203], a[132:135], v[52:55]
  v_max3_u32 v30, v30, v217, v218
  v_max3_u32 v30, v30, v219, v220
  v_mfma_f32_16x16x32_bf16 v[56:59], v[200:203], a[136:139], v[56:59]
  ds_write_b128 v20, a[248:251] offset:2048
  v_mfma_f32_16x16x32_bf16 v[60:63], v[200:203], a[140:143], v[60:63]
  v_max3_u32 v30, v30, v221, v222
  v_max_u32 v30, v30, v223
  v_mfma_f32_16x16x32_bf16 v[48:51], v[204:207], a[144:147], v[48:51]
  ds_write_b128 v20, a[252:255] offset:3072
  v_mfma_f32_16x16x32_bf16 v[52:55], v[204:207], a[148:151], v[52:55]
  v_cmp_eq_u32 vcc, -1, v30
  v_mfma_f32_16x16x32_bf16 v[56:59], v[204:207], a[152:155], v[56:59]
  v_mfma_f32_16x16x32_bf16 v[60:63], v[204:207], a[156:159], v[60:63]
L_hb13:
  s_cbranch_vccnz L_hr13
L_ho13:
  v_mfma_f32_16x16x32_bf16 v[48:51], v[208:211], a[160:163], v[48:51]
  s_waitcnt lgkmcnt(0)
  s_barrier
  v_mfma_f32_16x16x32_bf16 v[52:55], v[208:211], a[164:167], v[52:55]
  ds_read_b128 v[128:131], v21 offset:0
  v_mfma_f32_16x16x32_bf16 v[56:59], v[208:211], a[168:171], v[56:59]
  ds_read_b128 v[144:147], v21 offset:4096
  v_mfma_f32_16x16x32_bf16 v[60:63], v[208:211], a[172:175], v[60:63]
  ds_read_b128 v[224:227], v21 offset:8192
  v_mfma_f32_16x16x32_bf16 v[48:51], v[212:215], a[176:179], v[48:51]
  ds_read_b128 v[132:135], v21 offset:1024
  v_mfma_f32_16x16x32_bf16 v[52:55], v[212:215], a[180:183], v[52:55]
  ds_read_b128 v[148:151], v21 offset:5120
  v_mfma_f32_16x16x32_bf16 v[56:59], v[212:215], a[184:187], v[56:59]
  ds_read_b128 v[228:231], v21 offset:9216
  v_mfma_f32_16x16x32_bf16 v[60:63], v[212:215], a[188:191], v[60:63]
  ds_read_b128 v[136:139], v21 offset:2048
  v_mfma_f32_16x16x32_bf16 v[48:51], v[216:219], a[192:195], v[48:51]
  ds_read_b128 v[152:155], v21 offset:6144
  v_mfma_f32_16x16x32_bf16 v[52:55], v[216:219], a[196:199], v[52:55]
  ds_read_b128 v[232:235], v21 offset:10240
  v_mfma_f32_16x16x32_bf16 v[56:59], v[216:219], a[200:203], v[56:59]
  ds_read_b128 v[140:143], v21 offset:3072
  v_mfma_f32_16x16x32_bf16 v[60:63], v[216:219], a[204:207], v[60:63]
  ds_read_b128 v[156:159], v21 offset:7168
  v_mfma_f32_16x16x32_bf16 v[48:51], v[220:223], a[208:211], v[48:51]
  ds_read_b128 v[236:239], v21 offset:11264
  v_mfma_f32_16x16x32_bf16 v[52:55], v[220:223], a[212:215], v[52:55]
  v_mfma_f32_16x16x32_bf16 v[56:59], v[220:223], a[216:219], v[56:59]
  v_mfma_f32_16x16x32_bf16 v[60:63], v[220:223], a[220:223], v[60:63]
  s_waitcnt lgkmcnt(9)
  v_pk_add_f32 v[128:129], v[128:129], v[144:145]
  v_pk_add_f32 v[130:131], v[130:131], v[146:147]
  v_pk_add_f32 v[128:129], v[128:129], v[224:225]
  v_pk_add_f32 v[130:131], v[130:131], v[226:227]
  v_pk_add_f32 v[48:49], v[48:49], v[128:129]
  v_pk_add_f32 v[50:51], v[50:51], v[130:131]
  s_waitcnt lgkmcnt(6)
  v_pk_add_f32 v[132:133], v[132:133], v[148:149]
  v_pk_add_f32 v[134:135], v[134:135], v[150:151]
  v_pk_add_f32 v[132:133], v[132:133], v[228:229]
  v_pk_add_f32 v[134:135], v[134:135], v[230:231]
  v_pk_add_f32 v[52:53], v[52:53], v[132:133]
  v_pk_add_f32 v[54:55], v[54:55], v[134:135]
  s_waitcnt lgkmcnt(3)
  v_pk_add_f32 v[136:137], v[136:137], v[152:153]
  v_pk_add_f32 v[138:139], v[138:139], v[154:155]
  v_pk_add_f32 v[136:137], v[136:137], v[232:233]
  v_pk_add_f32 v[138:139], v[138:139], v[234:235]
  v_pk_add_f32 v[56:57], v[56:57], v[136:137]
  v_pk_add_f32 v[58:59], v[58:59], v[138:139]
  s_waitcnt lgkmcnt(0)
  v_pk_add_f32 v[140:141], v[140:141], v[156:157]
  v_pk_add_f32 v[142:143], v[142:143], v[158:159]
  v_pk_add_f32 v[140:141], v[140:141], v[236:237]
  v_pk_add_f32 v[142:143], v[142:143], v[238:239]
  v_pk_add_f32 v[60:61], v[60:61], v[140:141]
  v_pk_add_f32 v[62:63], v[62:63], v[142:143]
  v_pk_fma_f32 v[48:49], v[48:49], v[80:81], v[32:33] op_sel:[0,0,0] op_sel_hi:[1,0,1]
  v_pk_fma_f32 v[52:53], v[52:53], v[82:83], v[36:37] op_sel:[0,0,0] op_sel_hi:[1,0,1]
  v_pk_fma_f32 v[56:57], v[56:57], v[84:85], v[40:41] op_sel:[0,0,0] op_sel_hi:[1,0,1]
  v_pk_fma_f32 v[60:61], v[60:61], v[86:87], v[44:45] op_sel:[0,0,0] op_sel_hi:[1,0,1]
  v_cvt_pk_bf16_f32 v96, v48, v52
  v_cvt_pk_bf16_f32 v97, v56, v60
  buffer_store_dwordx2 v[96:97], v22, s[12:15], s26 offen offset:0 sc1
  v_cvt_pk_bf16_f32 v98, v49, v53
  v_cvt_pk_bf16_f32 v99, v57, v61
  buffer_store_dwordx2 v[98:99], v22, s[12:15], s26 offen offset:1024 sc1
  v_pk_fma_f32 v[50:51], v[50:51], v[80:81], v[34:35] op_sel:[0,0,0] op_sel_hi:[1,0,1]
  v_pk_fma_f32 v[54:55], v[54:55], v[82:83], v[38:39] op_sel:[0,0,0] op_sel_hi:[1,0,1]
  v_pk_fma_f32 v[58:59], v[58:59], v[84:85], v[42:43] op_sel:[0,0,0] op_sel_hi:[1,0,1]
  v_pk_fma_f32 v[62:63], v[62:63], v[86:87], v[46:47] op_sel:[0,0,0] op_sel_hi:[1,0,1]
  v_cvt_pk_bf16_f32 v100, v50, v54
  v_cvt_pk_bf16_f32 v101, v58, v62
  buffer_store_dwordx2 v[100:101], v22, s[12:15], s26 offen offset:2048 sc1
  v_cvt_pk_bf16_f32 v102, v51, v55
  v_cvt_pk_bf16_f32 v103, v59, v63
  buffer_store_dwordx2 v[102:103], v22, s[12:15], s26 offen offset:3072 sc1
  s_endpgm
L_stubs:
L_r1:
  s_add_u32 s51, s51, 1
  s_cmp_gt_u32 s51, 8192
  s_cbranch_scc1 L_o1
  buffer_load_dwordx4 v[224:227], v3, s[8:11], s68 offen offset:0 sc1
  buffer_load_dwordx4 v[228:231], v3, s[8:11], s68 offen offset:1024 sc1
  buffer_load_dwordx4 v[232:235], v3, s[8:11], s69 offen offset:0 sc1
  buffer_load_dwordx4 v[236:239], v3, s[8:11], s69 offen offset:1024 sc1
  buffer_load_dwordx4 v[192:195], v158, s[8:11], s72 offen sc1
  buffer_load_dwordx4 v[196:199], v158, s[8:11], s73 offen sc1
  buffer_load_dwordx2 v[200:201], v156, s[8:11], s70 offen sc1
  buffer_load_dwordx2 v[202:203], v157, s[8:11], s71 offen sc1
  s_waitcnt vmcnt(0)
  s_branch L_c1
L_rm:
  s_add_u32 s51, s51, 1
  s_cmp_gt_u32 s51, 8192
  s_cbranch_scc1 L_om
  buffer_load_dwordx4 v[192:195], v158, s[8:11], s72 offen sc1
  buffer_load_dwordx4 v[196:199], v158, s[8:11], s73 offen sc1
  buffer_load_dwordx2 v[200:201], v156, s[8:11], s70 offen sc1
  buffer_load_dwordx2 v[202:203], v157, s[8:11], s71 offen sc1
  s_waitcnt vmcnt(0)
  s_branch L_cm
L_r2a:
  s_add_u32 s51, s51, 1
  s_cmp_gt_u32 s51, 8192
  s_cbranch_scc1 L_o2a
  buffer_load_dword v255, v8, s[8:11], s76 offen sc1
  s_waitcnt vmcnt(0)
  v_cmp_ne_u32 vcc, s50, v255
  s_branch L_b2a
L_rall:
  s_add_u32 s51, s51, 1
  s_cmp_gt_u32 s51, 8192
  s_cbranch_scc1 L_oall
  buffer_load_dword v224, v31, s[8:11], s22 offen sc1
  buffer_load_dword v255, v24, s[8:11], s21 offen sc1
  s_waitcnt vmcnt(0)
  s_branch L_call
L_xr0:
  s_add_u32 s51, s51, 1
  s_cmp_gt_u32 s51, 10240
  s_cbranch_scc1 L_xo0
  s_add_u32 m0, s18, 131072
  s_add_u32 s7, s20, 0
  buffer_load_dwordx4 v12, s[8:11], s7 offen offset:0 sc1 lds
  buffer_load_dwordx4 v12, s[8:11], s7 offen offset:1024 sc1 lds
  buffer_load_dwordx4 v12, s[8:11], s7 offen offset:2048 sc1 lds
  buffer_load_dwordx4 v12, s[8:11], s7 offen offset:3072 sc1 lds
  s_add_u32 m0, s18, 135168
  s_add_u32 s7, s20, 4096
  buffer_load_dwordx4 v12, s[8:11], s7 offen offset:0 sc1 lds
  buffer_load_dwordx4 v12, s[8:11], s7 offen offset:1024 sc1 lds
  buffer_load_dwordx4 v12, s[8:11], s7 offen offset:2048 sc1 lds
  buffer_load_dwordx4 v12, s[8:11], s7 offen offset:3072 sc1 lds
  s_add_u32 m0, s18, 98304
  s_add_u32 s7, s20, 8192
  buffer_load_dwordx4 v12, s[8:11], s7 offen offset:0 sc1 lds
  buffer_load_dwordx4 v12, s[8:11], s7 offen offset:1024 sc1 lds
  buffer_load_dwordx4 v12, s[8:11], s7 offen offset:2048 sc1 lds
  buffer_load_dwordx4 v12, s[8:11], s7 offen offset:3072 sc1 lds
  s_add_u32 m0, s18, 102400
  s_add_u32 s7, s20, 12288
  buffer_load_dwordx4 v12, s[8:11], s7 offen offset:0 sc1 lds
  buffer_load_dwordx4 v12, s[8:11], s7 offen offset:1024 sc1 lds
  s_waitcnt vmcnt(0)
  ds_read_b64_tr_b16 v[128:129], v13 offset:32768
  ds_read_b64_tr_b16 v[130:131], v13 offset:33024
  ds_read_b64_tr_b16 v[132:133], v14 offset:32768
  ds_read_b64_tr_b16 v[134:135], v14 offset:33024
  ds_read_b64_tr_b16 v[136:137], v13 offset:34816
  ds_read_b64_tr_b16 v[138:139], v13 offset:35072
  ds_read_b64_tr_b16 v[140:141], v14 offset:34816
  ds_read_b64_tr_b16 v[142:143], v14 offset:35072
  s_add_u32 m0, s18, 102400
  s_waitcnt lgkmcnt(0)
  v_mfma_f32_16x16x32_bf16 v[112:115], v[96:99], v[128:131], 0
  v_mfma_f32_16x16x32_bf16 v[116:119], v[96:99], v[132:135], 0
  s_nop 7
  v_cmp_u_f32 vcc, v112, v116
  s_branch L_xb0
L_xr1:
  s_add_u32 s51, s51, 1
  s_cmp_gt_u32 s51, 10240
  s_cbranch_scc1 L_xo1
  s_add_u32 m0, s18, 131072
  s_add_u32 s7, s20, 0
  buffer_load_dwordx4 v12, s[8:11], s7 offen offset:2048 sc1 lds
  buffer_load_dwordx4 v12, s[8:11], s7 offen offset:3072 sc1 lds
  s_add_u32 m0, s18, 135168
  s_add_u32 s7, s20, 4096
  buffer_load_dwordx4 v12, s[8:11], s7 offen offset:0 sc1 lds
  buffer_load_dwordx4 v12, s[8:11], s7 offen offset:1024 sc1 lds
  buffer_load_dwordx4 v12, s[8:11], s7 offen offset:2048 sc1 lds
  buffer_load_dwordx4 v12, s[8:11], s7 offen offset:3072 sc1 lds
  s_add_u32 m0, s18, 98304
  s_add_u32 s7, s20, 8192
  buffer_load_dwordx4 v12, s[8:11], s7 offen offset:0 sc1 lds
  buffer_load_dwordx4 v12, s[8:11], s7 offen offset:1024 sc1 lds
  buffer_load_dwordx4 v12, s[8:11], s7 offen offset:2048 sc1 lds
  buffer_load_dwordx4 v12, s[8:11], s7 offen offset:3072 sc1 lds
  s_add_u32 m0, s18, 102400
  s_add_u32 s7, s20, 12288
  buffer_load_dwordx4 v12, s[8:11], s7 offen offset:0 sc1 lds
  buffer_load_dwordx4 v12, s[8:11], s7 offen offset:1024 sc1 lds
  buffer_load_dwordx4 v12, s[8:11], s7 offen offset:2048 sc1 lds
  buffer_load_dwordx4 v12, s[8:11], s7 offen offset:3072 sc1 lds
  s_waitcnt vmcnt(0)
  ds_read_b64_tr_b16 v[136:137], v13 offset:34816
  ds_read_b64_tr_b16 v[138:139], v13 offset:35072
  ds_read_b64_tr_b16 v[140:141], v14 offset:34816
  ds_read_b64_tr_b16 v[142:143], v14 offset:35072
  ds_read_b64_tr_b16 v[144:145], v13 offset:36864
  ds_read_b64_tr_b16 v[146:147], v13 offset:37120
  ds_read_b64_tr_b16 v[148:149], v14 offset:36864
  ds_read_b64_tr_b16 v[150:151], v14 offset:37120
  s_add_u32 m0, s18, 102400
  s_waitcnt lgkmcnt(0)
  v_mfma_f32_16x16x32_bf16 v[120:123], v[96:99], v[136:139], v[112:115]
  v_mfma_f32_16x16x32_bf16 v[124:127], v[96:99], v[140:143], v[116:119]
  s_nop 7
  v_cmp_u_f32 vcc, v120, v124
  s_branch L_xb1
L_xr2:
  s_add_u32 s51, s51, 1
  s_cmp_gt_u32 s51, 10240
  s_cbranch_scc1 L_xo2
  s_add_u32 m0, s18, 135168
  s_add_u32 s7, s20, 4096
  buffer_load_dwordx4 v12, s[8:11], s7 offen offset:0 sc1 lds
  buffer_load_dwordx4 v12, s[8:11], s7 offen offset:1024 sc1 lds
  buffer_load_dwordx4 v12, s[8:11], s7 offen offset:2048 sc1 lds
  buffer_load_dwordx4 v12, s[8:11], s7 offen offset:3072 sc1 lds
  s_add_u32 m0, s18, 98304
  s_add_u32 s7, s20, 8192
  buffer_load_dwordx4 v12, s[8:11], s7 offen offset:0 sc1 lds
  buffer_load_dwordx4 v12, s[8:11], s7 offen offset:1024 sc1 lds
  buffer_load_dwordx4 v12, s[8:11], s7 offen offset:2048 sc1 lds
  buffer_load_dwordx4 v12, s[8:11], s7 offen offset:3072 sc1 lds
  s_add_u32 m0, s18, 102400
  s_add_u32 s7, s20, 12288
  buffer_load_dwordx4 v12, s[8:11], s7 offen offset:0 sc1 lds
  buffer_load_dwordx4 v12, s[8:11], s7 offen offset:1024 sc1 lds
  buffer_load_dwordx4 v12, s[8:11], s7 offen offset:2048 sc1 lds
  buffer_load_dwordx4 v12, s[8:11], s7 offen offset:3072 sc1 lds
  s_add_u32 m0, s18, 131072
  s_add_u32 s7, s20, 16384
  buffer_load_dwordx4 v12, s[8:11], s7 offen offset:0 sc1 lds
  buffer_load_dwordx4 v12, s[8:11], s7 offen offset:1024 sc1 lds
  s_waitcnt vmcnt(0)
  ds_read_b64_tr_b16 v[144:145], v13 offset:36864
  ds_read_b64_tr_b16 v[146:147], v13 offset:37120
  ds_read_b64_tr_b16 v[148:149], v14 offset:36864
  ds_read_b64_tr_b16 v[150:151], v14 offset:37120
  ds_read_b64_tr_b16 v[152:153], v13 offset:38912
  ds_read_b64_tr_b16 v[154:155], v13 offset:39168
  ds_read_b64_tr_b16 v[156:157], v14 offset:38912
  ds_read_b64_tr_b16 v[158:159], v14 offset:39168
  s_add_u32 m0, s18, 131072
  s_waitcnt lgkmcnt(0)
  v_mfma_f32_16x16x32_bf16 v[112:115], v[96:99], v[144:147], v[120:123]
  v_mfma_f32_16x16x32_bf16 v[116:119], v[96:99], v[148:151], v[124:127]
  s_nop 7
  v_cmp_u_f32 vcc, v112, v116
  s_branch L_xb2
L_xr3:
  s_add_u32 s51, s51, 1
  s_cmp_gt_u32 s51, 10240
  s_cbranch_scc1 L_xo3
  s_add_u32 m0, s18, 135168
  s_add_u32 s7, s20, 4096
  buffer_load_dwordx4 v12, s[8:11], s7 offen offset:2048 sc1 lds
  buffer_load_dwordx4 v12, s[8:11], s7 offen offset:3072 sc1 lds
  s_add_u32 m0, s18, 98304
  s_add_u32 s7, s20, 8192
  buffer_load_dwordx4 v12, s[8:11], s7 offen offset:0 sc1 lds
  buffer_load_dwordx4 v12, s[8:11], s7 offen offset:1024 sc1 lds
  buffer_load_dwordx4 v12, s[8:11], s7 offen offset:2048 sc1 lds
  buffer_load_dwordx4 v12, s[8:11], s7 offen offset:3072 sc1 lds
  s_add_u32 m0, s18, 102400
  s_add_u32 s7, s20, 12288
  buffer_load_dwordx4 v12, s[8:11], s7 offen offset:0 sc1 lds
  buffer_load_dwordx4 v12, s[8:11], s7 offen offset:1024 sc1 lds
  buffer_load_dwordx4 v12, s[8:11], s7 offen offset:2048 sc1 lds
  buffer_load_dwordx4 v12, s[8:11], s7 offen offset:3072 sc1 lds
  s_add_u32 m0, s18, 131072
  s_add_u32 s7, s20, 16384
  buffer_load_dwordx4 v12, s[8:11], s7 offen offset:0 sc1 lds
  buffer_load_dwordx4 v12, s[8:11], s7 offen offset:1024 sc1 lds
  buffer_load_dwordx4 v12, s[8:11], s7 offen offset:2048 sc1 lds
  buffer_load_dwordx4 v12, s[8:11], s7 offen offset:3072 sc1 lds
  s_waitcnt vmcnt(0)
  ds_read_b64_tr_b16 v[152:153], v13 offset:38912
  ds_read_b64_tr_b16 v[154:155], v13 offset:39168
  ds_read_b64_tr_b16 v[156:157], v14 offset:38912
  ds_read_b64_tr_b16 v[158:159], v14 offset:39168
  ds_read_b64_tr_b16 v[160:161], v13 offset:0
  ds_read_b64_tr_b16 v[162:163], v13 offset:256
  ds_read_b64_tr_b16 v[164:165], v14 offset:0
  ds_read_b64_tr_b16 v[166:167], v14 offset:256
  s_add_u32 m0, s18, 131072
  s_waitcnt lgkmcnt(0)
  v_mfma_f32_16x16x32_bf16 v[120:123], v[96:99], v[152:155], v[112:115]
  v_mfma_f32_16x16x32_bf16 v[124:127], v[96:99], v[156:159], v[116:119]
  s_nop 7
  v_cmp_u_f32 vcc, v120, v124
  s_branch L_xb3
L_xr4:
  s_add_u32 s51, s51, 1
  s_cmp_gt_u32 s51, 10240
  s_cbranch_scc1 L_xo4
  s_add_u32 m0, s18, 98304
  s_add_u32 s7, s20, 8192
  buffer_load_dwordx4 v12, s[8:11], s7 offen offset:0 sc1 lds
  buffer_load_dwordx4 v12, s[8:11], s7 offen offset:1024 sc1 lds
  buffer_load_dwordx4 v12, s[8:11], s7 offen offset:2048 sc1 lds
  buffer_load_dwordx4 v12, s[8:11], s7 offen offset:3072 sc1 lds
  s_add_u32 m0, s18, 102400
  s_add_u32 s7, s20, 12288
  buffer_load_dwordx4 v12, s[8:11], s7 offen offset:0 sc1 lds
  buffer_load_dwordx4 v12, s[8:11], s7 offen offset:1024 sc1 lds
  buffer_load_dwordx4 v12, s[8:11], s7 offen offset:2048 sc1 lds
  buffer_load_dwordx4 v12, s[8:11], s7 offen offset:3072 sc1 lds
  s_add_u32 m0, s18, 131072
  s_add_u32 s7, s20, 16384
  buffer_load_dwordx4 v12, s[8:11], s7 offen offset:0 sc1 lds
  buffer_load_dwordx4 v12, s[8:11], s7 offen offset:1024 sc1 lds
  buffer_load_dwordx4 v12, s[8:11], s7 offen offset:2048 sc1 lds
  buffer_load_dwordx4 v12, s[8:11], s7 offen offset:3072 sc1 lds
  s_add_u32 m0, s18, 135168
  s_add_u32 s7, s20, 20480
  buffer_load_dwordx4 v12, s[8:11], s7 offen offset:0 sc1 lds
  buffer_load_dwordx4 v12, s[8:11], s7 offen offset:1024 sc1 lds
  s_waitcnt vmcnt(0)
  ds_read_b64_tr_b16 v[160:161], v13 offset:0
  ds_read_b64_tr_b16 v[162:163], v13 offset:256
  ds_read_b64_tr_b16 v[164:165], v14 offset:0
  ds_read_b64_tr_b16 v[166:167], v14 offset:256
  ds_read_b64_tr_b16 v[168:169], v13 offset:2048
  ds_read_b64_tr_b16 v[170:171], v13 offset:2304
  ds_read_b64_tr_b16 v[172:173], v14 offset:2048
  ds_read_b64_tr_b16 v[174:175], v14 offset:2304
  s_add_u32 m0, s18, 135168
  s_waitcnt lgkmcnt(0)
  v_mfma_f32_16x16x32_bf16 v[112:115], v[96:99], v[160:163], v[120:123]
  v_mfma_f32_16x16x32_bf16 v[116:119], v[96:99], v[164:167], v[124:127]
  s_nop 7
  v_cmp_u_f32 vcc, v112, v116
  s_branch L_xb4
L_xr5:
  s_add_u32 s51, s51, 1
  s_cmp_gt_u32 s51, 10240
  s_cbranch_scc1 L_xo5
  s_add_u32 m0, s18, 98304
  s_add_u32 s7, s20, 8192
  buffer_load_dwordx4 v12, s[8:11], s7 offen offset:2048 sc1 lds
  buffer_load_dwordx4 v12, s[8:11], s7 offen offset:3072 sc1 lds
  s_add_u32 m0, s18, 102400
  s_add_u32 s7, s20, 12288
  buffer_load_dwordx4 v12, s[8:11], s7 offen offset:0 sc1 lds
  buffer_load_dwordx4 v12, s[8:11], s7 offen offset:1024 sc1 lds
  buffer_load_dwordx4 v12, s[8:11], s7 offen offset:2048 sc1 lds
  buffer_load_dwordx4 v12, s[8:11], s7 offen offset:3072 sc1 lds
  s_add_u32 m0, s18, 131072
  s_add_u32 s7, s20, 16384
  buffer_load_dwordx4 v12, s[8:11], s7 offen offset:0 sc1 lds
  buffer_load_dwordx4 v12, s[8:11], s7 offen offset:1024 sc1 lds
  buffer_load_dwordx4 v12, s[8:11], s7 offen offset:2048 sc1 lds
  buffer_load_dwordx4 v12, s[8:11], s7 offen offset:3072 sc1 lds
  s_add_u32 m0, s18, 135168
  s_add_u32 s7, s20, 20480
  buffer_load_dwordx4 v12, s[8:11], s7 offen offset:0 sc1 lds
  buffer_load_dwordx4 v12, s[8:11], s7 offen offset:1024 sc1 lds
  buffer_load_dwordx4 v12, s[8:11], s7 offen offset:2048 sc1 lds
  buffer_load_dwordx4 v12, s[8:11], s7 offen offset:3072 sc1 lds
  s_waitcnt vmcnt(0)
  ds_read_b64_tr_b16 v[168:169], v13 offset:2048
  ds_read_b64_tr_b16 v[170:171], v13 offset:2304
  ds_read_b64_tr_b16 v[172:173], v14 offset:2048
  ds_read_b64_tr_b16 v[174:175], v14 offset:2304
  ds_read_b64_tr_b16 v[176:177], v13 offset:4096
  ds_read_b64_tr_b16 v[178:179], v13 offset:4352
  ds_read_b64_tr_b16 v[180:181], v14 offset:4096
  ds_read_b64_tr_b16 v[182:183], v14 offset:4352
  s_add_u32 m0, s18, 135168
  s_waitcnt lgkmcnt(0)
  v_mfma_f32_16x16x32_bf16 v[120:123], v[96:99], v[168:171], v[112:115]
  v_mfma_f32_16x16x32_bf16 v[124:127], v[96:99], v[172:175], v[116:119]
  s_nop 7
  v_cmp_u_f32 vcc, v120, v124
  s_branch L_xb5
L_xr6:
  s_add_u32 s51, s51, 1
  s_cmp_gt_u32 s51, 10240
  s_cbranch_scc1 L_xo6
  s_add_u32 m0, s18, 102400
  s_add_u32 s7, s20, 12288
  buffer_load_dwordx4 v12, s[8:11], s7 offen offset:0 sc1 lds
  buffer_load_dwordx4 v12, s[8:11], s7 offen offset:1024 sc1 lds
  buffer_load_dwordx4 v12, s[8:11], s7 offen offset:2048 sc1 lds
  buffer_load_dwordx4 v12, s[8:11], s7 offen offset:3072 sc1 lds
  s_add_u32 m0, s18, 131072
  s_add_u32 s7, s20, 16384
  buffer_load_dwordx4 v12, s[8:11], s7 offen offset:0 sc1 lds
  buffer_load_dwordx4 v12, s[8:11], s7 offen offset:1024 sc1 lds
  buffer_load_dwordx4 v12, s[8:11], s7 offen offset:2048 sc1 lds
  buffer_load_dwordx4 v12, s[8:11], s7 offen offset:3072 sc1 lds
  s_add_u32 m0, s18, 135168
  s_add_u32 s7, s20, 20480
  buffer_load_dwordx4 v12, s[8:11], s7 offen offset:0 sc1 lds
  buffer_load_dwordx4 v12, s[8:11], s7 offen offset:1024 sc1 lds
  buffer_load_dwordx4 v12, s[8:11], s7 offen offset:2048 sc1 lds
  buffer_load_dwordx4 v12, s[8:11], s7 offen offset:3072 sc1 lds
  s_add_u32 m0, s18, 98304
  s_add_u32 s7, s20, 24576
  buffer_load_dwordx4 v12, s[8:11], s7 offen offset:0 sc1 lds
  buffer_load_dwordx4 v12, s[8:11], s7 offen offset:1024 sc1 lds
  s_waitcnt vmcnt(0)
  ds_read_b64_tr_b16 v[176:177], v13 offset:4096
  ds_read_b64_tr_b16 v[178:179], v13 offset:4352
  ds_read_b64_tr_b16 v[180:181], v14 offset:4096
  ds_read_b64_tr_b16 v[182:183], v14 offset:4352
  ds_read_b64_tr_b16 v[184:185], v13 offset:6144
  ds_read_b64_tr_b16 v[186:187], v13 offset:6400
  ds_read_b64_tr_b16 v[188:189], v14 offset:6144
  ds_read_b64_tr_b16 v[190:191], v14 offset:6400
  s_add_u32 m0, s18, 98304
  s_waitcnt lgkmcnt(0)
  v_mfma_f32_16x16x32_bf16 v[112:115], v[96:99], v[176:179], v[120:123]
  v_mfma_f32_16x16x32_bf16 v[116:119], v[96:99], v[180:183], v[124:127]
  s_nop 7
  v_cmp_u_f32 vcc, v112, v116
  s_branch L_xb6
L_xr7:
  s_add_u32 s51, s51, 1
  s_cmp_gt_u32 s51, 10240
  s_cbranch_scc1 L_xo7
  s_add_u32 m0, s18, 102400
  s_add_u32 s7, s20, 12288
  buffer_load_dwordx4 v12, s[8:11], s7 offen offset:2048 sc1 lds
  buffer_load_dwordx4 v12, s[8:11], s7 offen offset:3072 sc1 lds
  s_add_u32 m0, s18, 131072
  s_add_u32 s7, s20, 16384
  buffer_load_dwordx4 v12, s[8:11], s7 offen offset:0 sc1 lds
  buffer_load_dwordx4 v12, s[8:11], s7 offen offset:1024 sc1 lds
  buffer_load_dwordx4 v12, s[8:11], s7 offen offset:2048 sc1 lds
  buffer_load_dwordx4 v12, s[8:11], s7 offen offset:3072 sc1 lds
  s_add_u32 m0, s18, 135168
  s_add_u32 s7, s20, 20480
  buffer_load_dwordx4 v12, s[8:11], s7 offen offset:0 sc1 lds
  buffer_load_dwordx4 v12, s[8:11], s7 offen offset:1024 sc1 lds
  buffer_load_dwordx4 v12, s[8:11], s7 offen offset:2048 sc1 lds
  buffer_load_dwordx4 v12, s[8:11], s7 offen offset:3072 sc1 lds
  s_add_u32 m0, s18, 98304
  s_add_u32 s7, s20, 24576
  buffer_load_dwordx4 v12, s[8:11], s7 offen offset:0 sc1 lds
  buffer_load_dwordx4 v12, s[8:11], s7 offen offset:1024 sc1 lds
  buffer_load_dwordx4 v12, s[8:11], s7 offen offset:2048 sc1 lds
  buffer_load_dwordx4 v12, s[8:11], s7 offen offset:3072 sc1 lds
  s_waitcnt vmcnt(0)
  ds_read_b64_tr_b16 v[184:185], v13 offset:6144
  ds_read_b64_tr_b16 v[186:187], v13 offset:6400
  ds_read_b64_tr_b16 v[188:189], v14 offset:6144
  ds_read_b64_tr_b16 v[190:191], v14 offset:6400
  ds_read_b64_tr_b16 v[192:193], v13 offset:32768
  ds_read_b64_tr_b16 v[194:195], v13 offset:33024
  ds_read_b64_tr_b16 v[196:197], v14 offset:32768
  ds_read_b64_tr_b16 v[198:199], v14 offset:33024
  s_add_u32 m0, s18, 98304
  s_waitcnt lgkmcnt(0)
  v_mfma_f32_16x16x32_bf16 v[120:123], v[96:99], v[184:187], v[112:115]
  v_mfma_f32_16x16x32_bf16 v[124:127], v[96:99], v[188:191], v[116:119]
  s_nop 7
  v_cmp_u_f32 vcc, v120, v124
  s_branch L_xb7
L_xr8:
  s_add_u32 s51, s51, 1
  s_cmp_gt_u32 s51, 10240
  s_cbranch_scc1 L_xo8
  s_add_u32 m0, s18, 131072
  s_add_u32 s7, s20, 16384
  buffer_load_dwordx4 v12, s[8:11], s7 offen offset:0 sc1 lds
  buffer_load_dwordx4 v12, s[8:11], s7 offen offset:1024 sc1 lds
  buffer_load_dwordx4 v12, s[8:11], s7 offen offset:2048 sc1 lds
  buffer_load_dwordx4 v12, s[8:11], s7 offen offset:3072 sc1 lds
  s_add_u32 m0, s18, 135168
  s_add_u32 s7, s20, 20480
  buffer_load_dwordx4 v12, s[8:11], s7 offen offset:0 sc1 lds
  buffer_load_dwordx4 v12, s[8:11], s7 offen offset:1024 sc1 lds
  buffer_load_dwordx4 v12, s[8:11], s7 offen offset:2048 sc1 lds
  buffer_load_dwordx4 v12, s[8:11], s7 offen offset:3072 sc1 lds
  s_add_u32 m0, s18, 98304
  s_add_u32 s7, s20, 24576
  buffer_load_dwordx4 v12, s[8:11], s7 offen offset:0 sc1 lds
  buffer_load_dwordx4 v12, s[8:11], s7 offen offset:1024 sc1 lds
  buffer_load_dwordx4 v12, s[8:11], s7 offen offset:2048 sc1 lds
  buffer_load_dwordx4 v12, s[8:11], s7 offen offset:3072 sc1 lds
  s_add_u32 m0, s18, 102400
  s_add_u32 s7, s20, 28672
  buffer_load_dwordx4 v12, s[8:11], s7 offen offset:0 sc1 lds
  buffer_load_dwordx4 v12, s[8:11], s7 offen offset:1024 sc1 lds
  s_waitcnt vmcnt(0)
  ds_read_b64_tr_b16 v[192:193], v13 offset:32768
  ds_read_b64_tr_b16 v[194:195], v13 offset:33024
  ds_read_b64_tr_b16 v[196:197], v14 offset:32768
  ds_read_b64_tr_b16 v[198:199], v14 offset:33024
  ds_read_b64_tr_b16 v[200:201], v13 offset:34816
  ds_read_b64_tr_b16 v[202:203], v13 offset:35072
  ds_read_b64_tr_b16 v[204:205], v14 offset:34816
  ds_read_b64_tr_b16 v[206:207], v14 offset:35072
  s_add_u32 m0, s18, 102400
  s_waitcnt lgkmcnt(0)
  v_mfma_f32_16x16x32_bf16 v[112:115], v[96:99], v[192:195], v[120:123]
  v_mfma_f32_16x16x32_bf16 v[116:119], v[96:99], v[196:199], v[124:127]
  s_nop 7
  v_cmp_u_f32 vcc, v112, v116
  s_branch L_xb8
L_xr9:
  s_add_u32 s51, s51, 1
  s_cmp_gt_u32 s51, 10240
  s_cbranch_scc1 L_xo9
  s_add_u32 m0, s18, 131072
  s_add_u32 s7, s20, 16384
  buffer_load_dwordx4 v12, s[8:11], s7 offen offset:2048 sc1 lds
  buffer_load_dwordx4 v12, s[8:11], s7 offen offset:3072 sc1 lds
  s_add_u32 m0, s18, 135168
  s_add_u32 s7, s20, 20480
  buffer_load_dwordx4 v12, s[8:11], s7 offen offset:0 sc1 lds
  buffer_load_dwordx4 v12, s[8:11], s7 offen offset:1024 sc1 lds
  buffer_load_dwordx4 v12, s[8:11], s7 offen offset:2048 sc1 lds
  buffer_load_dwordx4 v12, s[8:11], s7 offen offset:3072 sc1 lds
  s_add_u32 m0, s18, 98304
  s_add_u32 s7, s20, 24576
  buffer_load_dwordx4 v12, s[8:11], s7 offen offset:0 sc1 lds
  buffer_load_dwordx4 v12, s[8:11], s7 offen offset:1024 sc1 lds
  buffer_load_dwordx4 v12, s[8:11], s7 offen offset:2048 sc1 lds
  buffer_load_dwordx4 v12, s[8:11], s7 offen offset:3072 sc1 lds
  s_add_u32 m0, s18, 102400
  s_add_u32 s7, s20, 28672
  buffer_load_dwordx4 v12, s[8:11], s7 offen offset:0 sc1 lds
  buffer_load_dwordx4 v12, s[8:11], s7 offen offset:1024 sc1 lds
  buffer_load_dwordx4 v12, s[8:11], s7 offen offset:2048 sc1 lds
  buffer_load_dwordx4 v12, s[8:11], s7 offen offset:3072 sc1 lds
  s_waitcnt vmcnt(0)
  ds_read_b64_tr_b16 v[200:201], v13 offset:34816
  ds_read_b64_tr_b16 v[202:203], v13 offset:35072
  ds_read_b64_tr_b16 v[204:205], v14 offset:34816
  ds_read_b64_tr_b16 v[206:207], v14 offset:35072
  ds_read_b64_tr_b16 v[208:209], v13 offset:36864
  ds_read_b64_tr_b16 v[210:211], v13 offset:37120
  ds_read_b64_tr_b16 v[212:213], v14 offset:36864
  ds_read_b64_tr_b16 v[214:215], v14 offset:37120
  s_add_u32 m0, s18, 131072
  s_waitcnt lgkmcnt(0)
  v_mfma_f32_16x16x32_bf16 v[120:123], v[96:99], v[200:203], v[112:115]
  v_mfma_f32_16x16x32_bf16 v[124:127], v[96:99], v[204:207], v[116:119]
  s_nop 7
  v_cmp_u_f32 vcc, v120, v124
  s_branch L_xb9
L_xr10:
  s_add_u32 s51, s51, 1
  s_cmp_gt_u32 s51, 10240
  s_cbranch_scc1 L_xo10
  s_add_u32 m0, s18, 135168
  s_add_u32 s7, s20, 20480
  buffer_load_dwordx4 v12, s[8:11], s7 offen offset:0 sc1 lds
  buffer_load_dwordx4 v12, s[8:11], s7 offen offset:1024 sc1 lds
  buffer_load_dwordx4 v12, s[8:11], s7 offen offset:2048 sc1 lds
  buffer_load_dwordx4 v12, s[8:11], s7 offen offset:3072 sc1 lds
  s_add_u32 m0, s18, 98304
  s_add_u32 s7, s20, 24576
  buffer_load_dwordx4 v12, s[8:11], s7 offen offset:0 sc1 lds
  buffer_load_dwordx4 v12, s[8:11], s7 offen offset:1024 sc1 lds
  buffer_load_dwordx4 v12, s[8:11], s7 offen offset:2048 sc1 lds
  buffer_load_dwordx4 v12, s[8:11], s7 offen offset:3072 sc1 lds
  s_add_u32 m0, s18, 102400
  s_add_u32 s7, s20, 28672
  buffer_load_dwordx4 v12, s[8:11], s7 offen offset:0 sc1 lds
  buffer_load_dwordx4 v12, s[8:11], s7 offen offset:1024 sc1 lds
  buffer_load_dwordx4 v12, s[8:11], s7 offen offset:2048 sc1 lds
  buffer_load_dwordx4 v12, s[8:11], s7 offen offset:3072 sc1 lds
  s_waitcnt vmcnt(0)
  ds_read_b64_tr_b16 v[208:209], v13 offset:36864
  ds_read_b64_tr_b16 v[210:211], v13 offset:37120
  ds_read_b64_tr_b16 v[212:213], v14 offset:36864
  ds_read_b64_tr_b16 v[214:215], v14 offset:37120
  ds_read_b64_tr_b16 v[216:217], v13 offset:38912
  ds_read_b64_tr_b16 v[218:219], v13 offset:39168
  ds_read_b64_tr_b16 v[220:221], v14 offset:38912
  ds_read_b64_tr_b16 v[222:223], v14 offset:39168
  s_add_u32 m0, s18, 65536
  s_waitcnt lgkmcnt(0)
  v_mfma_f32_16x16x32_bf16 v[112:115], v[96:99], v[208:211], v[120:123]
  v_mfma_f32_16x16x32_bf16 v[116:119], v[96:99], v[212:215], v[124:127]
  s_nop 7
  v_cmp_u_f32 vcc, v112, v116
  s_branch L_xb10
L_xr11:
  s_add_u32 s51, s51, 1
  s_cmp_gt_u32 s51, 10240
  s_cbranch_scc1 L_xo11
  s_add_u32 m0, s18, 135168
  s_add_u32 s7, s20, 20480
  buffer_load_dwordx4 v12, s[8:11], s7 offen offset:2048 sc1 lds
  buffer_load_dwordx4 v12, s[8:11], s7 offen offset:3072 sc1 lds
  s_add_u32 m0, s18, 98304
  s_add_u32 s7, s20, 24576
  buffer_load_dwordx4 v12, s[8:11], s7 offen offset:0 sc1 lds
  buffer_load_dwordx4 v12, s[8:11], s7 offen offset:1024 sc1 lds
  buffer_load_dwordx4 v12, s[8:11], s7 offen offset:2048 sc1 lds
  buffer_load_dwordx4 v12, s[8:11], s7 offen offset:3072 sc1 lds
  s_add_u32 m0, s18, 102400
  s_add_u32 s7, s20, 28672
  buffer_load_dwordx4 v12, s[8:11], s7 offen offset:0 sc1 lds
  buffer_load_dwordx4 v12, s[8:11], s7 offen offset:1024 sc1 lds
  buffer_load_dwordx4 v12, s[8:11], s7 offen offset:2048 sc1 lds
  buffer_load_dwordx4 v12, s[8:11], s7 offen offset:3072 sc1 lds
  s_waitcnt vmcnt(0)
  ds_read_b64_tr_b16 v[216:217], v13 offset:38912
  ds_read_b64_tr_b16 v[218:219], v13 offset:39168
  ds_read_b64_tr_b16 v[220:221], v14 offset:38912
  ds_read_b64_tr_b16 v[222:223], v14 offset:39168
  ds_read_b64_tr_b16 v[224:225], v13 offset:0
  ds_read_b64_tr_b16 v[226:227], v13 offset:256
  ds_read_b64_tr_b16 v[228:229], v14 offset:0
  ds_read_b64_tr_b16 v[230:231], v14 offset:256
  s_add_u32 m0, s18, 69632
  s_waitcnt lgkmcnt(0)
  v_mfma_f32_16x16x32_bf16 v[120:123], v[96:99], v[216:219], v[112:115]
  v_mfma_f32_16x16x32_bf16 v[124:127], v[96:99], v[220:223], v[116:119]
  s_nop 7
  v_cmp_u_f32 vcc, v120, v124
  s_branch L_xb11
L_xr12:
  s_add_u32 s51, s51, 1
  s_cmp_gt_u32 s51, 10240
  s_cbranch_scc1 L_xo12
  s_add_u32 m0, s18, 98304
  s_add_u32 s7, s20, 24576
  buffer_load_dwordx4 v12, s[8:11], s7 offen offset:0 sc1 lds
  buffer_load_dwordx4 v12, s[8:11], s7 offen offset:1024 sc1 lds
  buffer_load_dwordx4 v12, s[8:11], s7 offen offset:2048 sc1 lds
  buffer_load_dwordx4 v12, s[8:11], s7 offen offset:3072 sc1 lds
  s_add_u32 m0, s18, 102400
  s_add_u32 s7, s20, 28672
  buffer_load_dwordx4 v12, s[8:11], s7 offen offset:0 sc1 lds
  buffer_load_dwordx4 v12, s[8:11], s7 offen offset:1024 sc1 lds
  buffer_load_dwordx4 v12, s[8:11], s7 offen offset:2048 sc1 lds
  buffer_load_dwordx4 v12, s[8:11], s7 offen offset:3072 sc1 lds
  s_waitcnt vmcnt(0)
  ds_read_b64_tr_b16 v[224:225], v13 offset:0
  ds_read_b64_tr_b16 v[226:227], v13 offset:256
  ds_read_b64_tr_b16 v[228:229], v14 offset:0
  ds_read_b64_tr_b16 v[230:231], v14 offset:256
  ds_read_b64_tr_b16 v[232:233], v13 offset:2048
  ds_read_b64_tr_b16 v[234:235], v13 offset:2304
  ds_read_b64_tr_b16 v[236:237], v14 offset:2048
  ds_read_b64_tr_b16 v[238:239], v14 offset:2304
  s_add_u32 m0, s18, 69632
  s_waitcnt lgkmcnt(0)
  v_mfma_f32_16x16x32_bf16 v[112:115], v[96:99], v[224:227], v[120:123]
  v_mfma_f32_16x16x32_bf16 v[116:119], v[96:99], v[228:231], v[124:127]
  s_nop 7
  v_cmp_u_f32 vcc, v112, v116
  s_branch L_xb12
L_xr13:
  s_add_u32 s51, s51, 1
  s_cmp_gt_u32 s51, 10240
  s_cbranch_scc1 L_xo13
  s_add_u32 m0, s18, 98304
  s_add_u32 s7, s20, 24576
  buffer_load_dwordx4 v12, s[8:11], s7 offen offset:2048 sc1 lds
  buffer_load_dwordx4 v12, s[8:11], s7 offen offset:3072 sc1 lds
  s_add_u32 m0, s18, 102400
  s_add_u32 s7, s20, 28672
  buffer_load_dwordx4 v12, s[8:11], s7 offen offset:0 sc1 lds
  buffer_load_dwordx4 v12, s[8:11], s7 offen offset:1024 sc1 lds
  buffer_load_dwordx4 v12, s[8:11], s7 offen offset:2048 sc1 lds
  buffer_load_dwordx4 v12, s[8:11], s7 offen offset:3072 sc1 lds
  s_waitcnt vmcnt(0)
  ds_read_b64_tr_b16 v[232:233], v13 offset:2048
  ds_read_b64_tr_b16 v[234:235], v13 offset:2304
  ds_read_b64_tr_b16 v[236:237], v14 offset:2048
  ds_read_b64_tr_b16 v[238:239], v14 offset:2304
  ds_read_b64_tr_b16 v[240:241], v13 offset:4096
  ds_read_b64_tr_b16 v[242:243], v13 offset:4352
  ds_read_b64_tr_b16 v[244:245], v14 offset:4096
  ds_read_b64_tr_b16 v[246:247], v14 offset:4352
  s_add_u32 m0, s18, 69632
  s_waitcnt lgkmcnt(0)
  v_mfma_f32_16x16x32_bf16 v[120:123], v[96:99], v[232:235], v[112:115]
  v_mfma_f32_16x16x32_bf16 v[124:127], v[96:99], v[236:239], v[116:119]
  s_nop 7
  v_cmp_u_f32 vcc, v120, v124
  s_branch L_xb13
L_xr14:
  s_add_u32 s51, s51, 1
  s_cmp_gt_u32 s51, 10240
  s_cbranch_scc1 L_xo14
  s_add_u32 m0, s18, 102400
  s_add_u32 s7, s20, 28672
  buffer_load_dwordx4 v12, s[8:11], s7 offen offset:0 sc1 lds
  buffer_load_dwordx4 v12, s[8:11], s7 offen offset:1024 sc1 lds
  buffer_load_dwordx4 v12, s[8:11], s7 offen offset:2048 sc1 lds
  buffer_load_dwordx4 v12, s[8:11], s7 offen offset:3072 sc1 lds
  s_waitcnt vmcnt(0)
  ds_read_b64_tr_b16 v[240:241], v13 offset:4096
  ds_read_b64_tr_b16 v[242:243], v13 offset:4352
  ds_read_b64_tr_b16 v[244:245], v14 offset:4096
  ds_read_b64_tr_b16 v[246:247], v14 offset:4352
  ds_read_b64_tr_b16 v[248:249], v13 offset:6144
  ds_read_b64_tr_b16 v[250:251], v13 offset:6400
  ds_read_b64_tr_b16 v[252:253], v14 offset:6144
  ds_read_b64_tr_b16 v[254:255], v14 offset:6400
  s_add_u32 m0, s18, 98304
  s_waitcnt lgkmcnt(0)
  v_mfma_f32_16x16x32_bf16 v[112:115], v[96:99], v[240:243], v[120:123]
  v_mfma_f32_16x16x32_bf16 v[116:119], v[96:99], v[244:247], v[124:127]
  s_nop 7
  v_cmp_u_f32 vcc, v112, v116
  s_branch L_xb14
L_xr15:
  s_add_u32 s51, s51, 1
  s_cmp_gt_u32 s51, 10240
  s_cbranch_scc1 L_xo15
  s_add_u32 m0, s18, 102400
  s_add_u32 s7, s20, 28672
  buffer_load_dwordx4 v12, s[8:11], s7 offen offset:2048 sc1 lds
  buffer_load_dwordx4 v12, s[8:11], s7 offen offset:3072 sc1 lds
  s_waitcnt vmcnt(0)
  ds_read_b64_tr_b16 v[248:249], v13 offset:6144
  ds_read_b64_tr_b16 v[250:251], v13 offset:6400
  ds_read_b64_tr_b16 v[252:253], v14 offset:6144
  ds_read_b64_tr_b16 v[254:255], v14 offset:6400
  s_add_u32 m0, s18, 98304
  s_waitcnt lgkmcnt(0)
  v_mfma_f32_16x16x32_bf16 v[120:123], v[96:99], v[248:251], v[112:115]
  v_mfma_f32_16x16x32_bf16 v[124:127], v[96:99], v[252:255], v[116:119]
  s_nop 7
  v_cmp_u_f32 vcc, v120, v124
  s_branch L_xb15
L_rhf:
  s_add_u32 s51, s51, 1
  s_cmp_gt_u32 s51, 8192
  s_cbranch_scc1 L_ohf
  buffer_load_dword v9, v8, s[8:11], s30 offen sc1
  s_waitcnt vmcnt(0)
  v_cmp_ne_u32 vcc, s50, v9
  s_branch L_bhf
L_hr4:
  s_add_u32 s51, s51, 1
  s_cmp_gt_u32 s51, 40960
  s_cbranch_scc1 L_ho4
  buffer_load_dwordx4 v[192:195], v5, s[8:11], s40 offen offset:2048 sc1
  buffer_load_dwordx4 v[196:199], v6, s[8:11], s40 offen offset:2048 sc1
  buffer_load_dwordx4 v[200:203], v7, s[8:11], s40 offen offset:2048 sc1
  buffer_load_dwordx4 v[204:207], v4, s[8:11], s40 offen offset:2048 sc1
  buffer_load_dwordx4 v[208:211], v5, s[8:11], s42 offen offset:2048 sc1
  buffer_load_dwordx4 v[212:215], v6, s[8:11], s42 offen offset:2048 sc1
  buffer_load_dwordx4 v[216:219], v7, s[8:11], s42 offen offset:2048 sc1
  buffer_load_dwordx4 v[220:223], v4, s[8:11], s42 offen offset:2048 sc1
  buffer_load_dwordx4 v[224:227], v5, s[8:11], s40 offen offset:3072 sc1
  buffer_load_dwordx4 v[228:231], v6, s[8:11], s40 offen offset:3072 sc1
  buffer_load_dwordx4 v[232:235], v7, s[8:11], s40 offen offset:3072 sc1
  buffer_load_dwordx4 v[236:239], v4, s[8:11], s40 offen offset:3072 sc1
  s_waitcnt vmcnt(0)
  v_max3_u32 v30, v192, v193, v194
  v_max3_u32 v30, v30, v195, v196
  v_max3_u32 v30, v30, v197, v198
  v_max3_u32 v30, v30, v199, v200
  v_max3_u32 v30, v30, v201, v202
  v_max3_u32 v30, v30, v203, v204
  v_max3_u32 v30, v30, v205, v206
  v_max_u32 v30, v30, v207
  v_cmp_eq_u32 vcc, -1, v30
  s_branch L_hb4
L_hr5:
  s_add_u32 s51, s51, 1
  s_cmp_gt_u32 s51, 40960
  s_cbranch_scc1 L_ho5
  buffer_load_dwordx4 v[208:211], v5, s[8:11], s42 offen offset:2048 sc1
  buffer_load_dwordx4 v[212:215], v6, s[8:11], s42 offen offset:2048 sc1
  buffer_load_dwordx4 v[216:219], v7, s[8:11], s42 offen offset:2048 sc1
  buffer_load_dwordx4 v[220:223], v4, s[8:11], s42 offen offset:2048 sc1
  buffer_load_dwordx4 v[224:227], v5, s[8:11], s40 offen offset:3072 sc1
  buffer_load_dwordx4 v[228:231], v6, s[8:11], s40 offen offset:3072 sc1
  buffer_load_dwordx4 v[232:235], v7, s[8:11], s40 offen offset:3072 sc1
  buffer_load_dwordx4 v[236:239], v4, s[8:11], s40 offen offset:3072 sc1
  buffer_load_dwordx4 v[240:243], v5, s[8:11], s42 offen offset:3072 sc1
  buffer_load_dwordx4 v[244:247], v6, s[8:11], s42 offen offset:3072 sc1
  buffer_load_dwordx4 v[248:251], v7, s[8:11], s42 offen offset:3072 sc1
  buffer_load_dwordx4 v[252:255], v5, s[8:11], s41 offen offset:0 sc1
  s_waitcnt vmcnt(0)
  v_max3_u32 v30, v208, v209, v210
  v_max3_u32 v30, v30, v211, v212
  v_max3_u32 v30, v30, v213, v214
  v_max3_u32 v30, v30, v215, v216
  v_max3_u32 v30, v30, v217, v218
  v_max3_u32 v30, v30, v219, v220
  v_max3_u32 v30, v30, v221, v222
  v_max_u32 v30, v30, v223
  v_cmp_eq_u32 vcc, -1, v30
  s_branch L_hb5
L_hr6:
  s_add_u32 s51, s51, 1
  s_cmp_gt_u32 s51, 40960
  s_cbranch_scc1 L_ho6
  buffer_load_dwordx4 v[224:227], v5, s[8:11], s40 offen offset:3072 sc1
  buffer_load_dwordx4 v[228:231], v6, s[8:11], s40 offen offset:3072 sc1
  buffer_load_dwordx4 v[232:235], v7, s[8:11], s40 offen offset:3072 sc1
  buffer_load_dwordx4 v[236:239], v4, s[8:11], s40 offen offset:3072 sc1
  buffer_load_dwordx4 v[240:243], v5, s[8:11], s42 offen offset:3072 sc1
  buffer_load_dwordx4 v[244:247], v6, s[8:11], s42 offen offset:3072 sc1
  buffer_load_dwordx4 v[248:251], v7, s[8:11], s42 offen offset:3072 sc1
  buffer_load_dwordx4 v[252:255], v5, s[8:11], s41 offen offset:0 sc1
  buffer_load_dwordx4 v[128:131], v6, s[8:11], s41 offen offset:0 sc1
  buffer_load_dwordx4 v[132:135], v7, s[8:11], s41 offen offset:0 sc1
  buffer_load_dwordx4 v[136:139], v5, s[8:11], s43 offen offset:0 sc1
  buffer_load_dwordx4 v[140:143], v6, s[8:11], s43 offen offset:0 sc1
  s_waitcnt vmcnt(0)
  v_max3_u32 v30, v224, v225, v226
  v_max3_u32 v30, v30, v227, v228
  v_max3_u32 v30, v30, v229, v230
  v_max3_u32 v30, v30, v231, v232
  v_max3_u32 v30, v30, v233, v234
  v_max3_u32 v30, v30, v235, v236
  v_max3_u32 v30, v30, v237, v238
  v_max_u32 v30, v30, v239
  v_cmp_eq_u32 vcc, -1, v30
  s_branch L_hb6
L_hr7:
  s_add_u32 s51, s51, 1
  s_cmp_gt_u32 s51, 40960
  s_cbranch_scc1 L_ho7
  buffer_load_dwordx4 v[240:243], v5, s[8:11], s42 offen offset:3072 sc1
  buffer_load_dwordx4 v[244:247], v6, s[8:11], s42 offen offset:3072 sc1
  buffer_load_dwordx4 v[248:251], v7, s[8:11], s42 offen offset:3072 sc1
  buffer_load_dwordx4 v[252:255], v5, s[8:11], s41 offen offset:0 sc1
  buffer_load_dwordx4 v[128:131], v6, s[8:11], s41 offen offset:0 sc1
  buffer_load_dwordx4 v[132:135], v7, s[8:11], s41 offen offset:0 sc1
  buffer_load_dwordx4 v[136:139], v5, s[8:11], s43 offen offset:0 sc1
  buffer_load_dwordx4 v[140:143], v6, s[8:11], s43 offen offset:0 sc1
  buffer_load_dwordx4 v[144:147], v7, s[8:11], s43 offen offset:0 sc1
  buffer_load_dwordx4 v[148:151], v5, s[8:11], s41 offen offset:1024 sc1
  buffer_load_dwordx4 v[152:155], v6, s[8:11], s41 offen offset:1024 sc1
  buffer_load_dwordx4 v[156:159], v7, s[8:11], s41 offen offset:1024 sc1
  s_waitcnt vmcnt(0)
  v_max3_u32 v30, v240, v241, v242
  v_max3_u32 v30, v30, v243, v244
  v_max3_u32 v30, v30, v245, v246
  v_max3_u32 v30, v30, v247, v248
  v_max3_u32 v30, v30, v249, v250
  v_max3_u32 v30, v30, v251, v252
  v_max3_u32 v30, v30, v253, v254
  v_max_u32 v30, v30, v255
  v_cmp_eq_u32 vcc, -1, v30
  s_branch L_hb7
L_hr8:
  s_add_u32 s51, s51, 1
  s_cmp_gt_u32 s51, 40960
  s_cbranch_scc1 L_ho8
  buffer_load_dwordx4 v[128:131], v6, s[8:11], s41 offen offset:0 sc1
  buffer_load_dwordx4 v[132:135], v7, s[8:11], s41 offen offset:0 sc1
  buffer_load_dwordx4 v[136:139], v5, s[8:11], s43 offen offset:0 sc1
  buffer_load_dwordx4 v[140:143], v6, s[8:11], s43 offen offset:0 sc1
  buffer_load_dwordx4 v[144:147], v7, s[8:11], s43 offen offset:0 sc1
  buffer_load_dwordx4 v[148:151], v5, s[8:11], s41 offen offset:1024 sc1
  buffer_load_dwordx4 v[152:155], v6, s[8:11], s41 offen offset:1024 sc1
  buffer_load_dwordx4 v[156:159], v7, s[8:11], s41 offen offset:1024 sc1
  buffer_load_dwordx4 v[160:163], v5, s[8:11], s43 offen offset:1024 sc1
  buffer_load_dwordx4 v[164:167], v6, s[8:11], s43 offen offset:1024 sc1
  buffer_load_dwordx4 v[168:171], v7, s[8:11], s43 offen offset:1024 sc1
  buffer_load_dwordx4 v[172:175], v5, s[8:11], s41 offen offset:2048 sc1
  s_waitcnt vmcnt(0)
  v_max3_u32 v30, v128, v129, v130
  v_max3_u32 v30, v30, v131, v132
  v_max3_u32 v30, v30, v133, v134
  v_max3_u32 v30, v30, v135, v136
  v_max3_u32 v30, v30, v137, v138
  v_max3_u32 v30, v30, v139, v140
  v_max3_u32 v30, v30, v141, v142
  v_max_u32 v30, v30, v143
  v_cmp_eq_u32 vcc, -1, v30
  s_branch L_hb8
L_hr9:
  s_add_u32 s51, s51, 1
  s_cmp_gt_u32 s51, 40960
  s_cbranch_scc1 L_ho9
  buffer_load_dwordx4 v[144:147], v7, s[8:11], s43 offen offset:0 sc1
  buffer_load_dwordx4 v[148:151], v5, s[8:11], s41 offen offset:1024 sc1
  buffer_load_dwordx4 v[152:155], v6, s[8:11], s41 offen offset:1024 sc1
  buffer_load_dwordx4 v[156:159], v7, s[8:11], s41 offen offset:1024 sc1
  buffer_load_dwordx4 v[160:163], v5, s[8:11], s43 offen offset:1024 sc1
  buffer_load_dwordx4 v[164:167], v6, s[8:11], s43 offen offset:1024 sc1
  buffer_load_dwordx4 v[168:171], v7, s[8:11], s43 offen offset:1024 sc1
  buffer_load_dwordx4 v[172:175], v5, s[8:11], s41 offen offset:2048 sc1
  buffer_load_dwordx4 v[176:179], v5, s[8:11], s43 offen offset:2048 sc1
  buffer_load_dwordx4 v[180:183], v6, s[8:11], s41 offen offset:2048 sc1
  buffer_load_dwordx4 v[184:187], v6, s[8:11], s43 offen offset:2048 sc1
  buffer_load_dwordx4 v[188:191], v7, s[8:11], s41 offen offset:2048 sc1
  s_waitcnt vmcnt(0)
  v_max3_u32 v30, v144, v145, v146
  v_max3_u32 v30, v30, v147, v148
  v_max3_u32 v30, v30, v149, v150
  v_max3_u32 v30, v30, v151, v152
  v_max3_u32 v30, v30, v153, v154
  v_max3_u32 v30, v30, v155, v156
  v_max3_u32 v30, v30, v157, v158
  v_max_u32 v30, v30, v159
  v_cmp_eq_u32 vcc, -1, v30
  s_branch L_hb9
L_hr10:
  s_add_u32 s51, s51, 1
  s_cmp_gt_u32 s51, 40960
  s_cbranch_scc1 L_ho10
  buffer_load_dwordx4 v[160:163], v5, s[8:11], s43 offen offset:1024 sc1
  buffer_load_dwordx4 v[164:167], v6, s[8:11], s43 offen offset:1024 sc1
  buffer_load_dwordx4 v[168:171], v7, s[8:11], s43 offen offset:1024 sc1
  buffer_load_dwordx4 v[172:175], v5, s[8:11], s41 offen offset:2048 sc1
  buffer_load_dwordx4 v[176:179], v5, s[8:11], s43 offen offset:2048 sc1
  buffer_load_dwordx4 v[180:183], v6, s[8:11], s41 offen offset:2048 sc1
  buffer_load_dwordx4 v[184:187], v6, s[8:11], s43 offen offset:2048 sc1
  buffer_load_dwordx4 v[188:191], v7, s[8:11], s41 offen offset:2048 sc1
  buffer_load_dwordx4 v[192:195], v7, s[8:11], s43 offen offset:2048 sc1
  buffer_load_dwordx4 v[196:199], v4, s[8:11], s42 offen offset:3072 sc1
  buffer_load_dwordx4 v[200:203], v4, s[8:11], s41 offen offset:0 sc1
  buffer_load_dwordx4 v[204:207], v4, s[8:11], s43 offen offset:0 sc1
  s_waitcnt vmcnt(0)
  v_max3_u32 v30, v160, v161, v162
  v_max3_u32 v30, v30, v163, v164
  v_max3_u32 v30, v30, v165, v166
  v_max3_u32 v30, v30, v167, v168
  v_max3_u32 v30, v30, v169, v170
  v_max3_u32 v30, v30, v171, v172
  v_max3_u32 v30, v30, v173, v174
  v_max_u32 v30, v30, v175
  v_cmp_eq_u32 vcc, -1, v30
  s_branch L_hb10
L_hr11:
  s_add_u32 s51, s51, 1
  s_cmp_gt_u32 s51, 40960
  s_cbranch_scc1 L_ho11
  buffer_load_dwordx4 v[176:179], v5, s[8:11], s43 offen offset:2048 sc1
  buffer_load_dwordx4 v[180:183], v6, s[8:11], s41 offen offset:2048 sc1
  buffer_load_dwordx4 v[184:187], v6, s[8:11], s43 offen offset:2048 sc1
  buffer_load_dwordx4 v[188:191], v7, s[8:11], s41 offen offset:2048 sc1
  buffer_load_dwordx4 v[192:195], v7, s[8:11], s43 offen offset:2048 sc1
  buffer_load_dwordx4 v[196:199], v4, s[8:11], s42 offen offset:3072 sc1
  buffer_load_dwordx4 v[200:203], v4, s[8:11], s41 offen offset:0 sc1
  buffer_load_dwordx4 v[204:207], v4, s[8:11], s43 offen offset:0 sc1
  buffer_load_dwordx4 v[208:211], v4, s[8:11], s41 offen offset:1024 sc1
  buffer_load_dwordx4 v[212:215], v4, s[8:11], s43 offen offset:1024 sc1
  buffer_load_dwordx4 v[216:219], v4, s[8:11], s41 offen offset:2048 sc1
  buffer_load_dwordx4 v[220:223], v4, s[8:11], s43 offen offset:2048 sc1
  s_waitcnt vmcnt(0)
  v_max3_u32 v30, v176, v177, v178
  v_max3_u32 v30, v30, v179, v180
  v_max3_u32 v30, v30, v181, v182
  v_max3_u32 v30, v30, v183, v184
  v_max3_u32 v30, v30, v185, v186
  v_max3_u32 v30, v30, v187, v188
  v_max3_u32 v30, v30, v189, v190
  v_max_u32 v30, v30, v191
  v_cmp_eq_u32 vcc, -1, v30
  s_branch L_hb11
L_hr12:
  s_add_u32 s51, s51, 1
  s_cmp_gt_u32 s51, 40960
  s_cbranch_scc1 L_ho12
  buffer_load_dwordx4 v[192:195], v7, s[8:11], s43 offen offset:2048 sc1
  buffer_load_dwordx4 v[196:199], v4, s[8:11], s42 offen offset:3072 sc1
  buffer_load_dwordx4 v[200:203], v4, s[8:11], s41 offen offset:0 sc1
  buffer_load_dwordx4 v[204:207], v4, s[8:11], s43 offen offset:0 sc1
  buffer_load_dwordx4 v[208:211], v4, s[8:11], s41 offen offset:1024 sc1
  buffer_load_dwordx4 v[212:215], v4, s[8:11], s43 offen offset:1024 sc1
  buffer_load_dwordx4 v[216:219], v4, s[8:11], s41 offen offset:2048 sc1
  buffer_load_dwordx4 v[220:223], v4, s[8:11], s43 offen offset:2048 sc1
  s_waitcnt vmcnt(0)
  v_max3_u32 v30, v192, v193, v194
  v_max3_u32 v30, v30, v195, v196
  v_max3_u32 v30, v30, v197, v198
  v_max3_u32 v30, v30, v199, v200
  v_max3_u32 v30, v30, v201, v202
  v_max3_u32 v30, v30, v203, v204
  v_max3_u32 v30, v30, v205, v206
  v_max_u32 v30, v30, v207
  v_cmp_eq_u32 vcc, -1, v30
  s_branch L_hb12
L_hr13:
  s_add_u32 s51, s51, 1
  s_cmp_gt_u32 s51, 40960
  s_cbranch_scc1 L_ho13
  buffer_load_dwordx4 v[208:211], v4, s[8:11], s41 offen offset:1024 sc1
  buffer_load_dwordx4 v[212:215], v4, s[8:11], s43 offen offset:1024 sc1
  buffer_load_dwordx4 v[216:219], v4, s[8:11], s41 offen offset:2048 sc1
  buffer_load_dwordx4 v[220:223], v4, s[8:11], s43 offen offset:2048 sc1
  s_waitcnt vmcnt(0)
  v_max3_u32 v30, v208, v209, v210
  v_max3_u32 v30, v30, v211, v212
  v_max3_u32 v30, v30, v213, v214
  v_max3_u32 v30, v30, v215, v216
  v_max3_u32 v30, v30, v217, v218
  v_max3_u32 v30, v30, v219, v220
  v_max3_u32 v30, v30, v221, v222
  v_max_u32 v30, v30, v223
  v_cmp_eq_u32 vcc, -1, v30
  s_branch L_hb13
L_end:
  s_endpgm
L_fin:
.if (L_fin-L_begin) < 33024
.fill (33024-(L_fin-L_begin))/4, 4, 0xbf800000
.endif
Ltext_end:
.section .rodata,"a"
.p2align 6
.amdhsa_kernel adaLN_cond__ssm_conv_s4d__glu_gated_glu__prompt_kernel
  .amdhsa_next_free_vgpr 512
  .amdhsa_next_free_sgpr 102
  .amdhsa_accum_offset 256
  .amdhsa_group_segment_fixed_size 0
  .amdhsa_kernarg_size 128
  .amdhsa_user_sgpr_count 2
  .amdhsa_user_sgpr_kernarg_segment_ptr 1
  .amdhsa_system_sgpr_workgroup_id_x 1
.end_amdhsa_kernel
```
